```python
import torch

def _softmax(x, axis=-1):
    return torch.softmax(x, dim=axis)
def _gelu(x):
    return torch.nn.functional.gelu(x, approximate="tanh")
def _silu(x):
    return torch.nn.functional.silu(x)
def _sigmoid(x):
    return torch.sigmoid(x)
def _layernorm(x, axis=-1, eps=1e-5):
    m = x.mean(dim=axis, keepdim=True)
    v = x.var(dim=axis, keepdim=True, unbiased=False)
    return (x - m) / torch.sqrt(v + eps)
def _scatter_add(tgt, idx, src, axis=0):
    return tgt.clone().index_add_(axis, idx, src)
def _segment_sum(src, seg, n):
    out = torch.zeros((n,) + src.shape[1:], dtype=src.dtype)
    return out.index_add_(0, seg, src)
def _pad(x, pw):
    flat = tuple(v for pair in reversed(pw) for v in pair)
    return torch.nn.functional.pad(x, flat)

kernel_name = 'standalone__linear_kernel_performer__prompt'

def setup_inputs():

    _w = (lambda a: (lambda t: t.to(torch.bfloat16) if t.is_floating_point() else t)(torch.as_tensor(a)))
    B, H, S, D = 1, 32, 2048, 128
    M = D
    return {
        "q": _w((lambda *s: torch.randn(*s, dtype=torch.bfloat16) * 0.05)(B, H, S, D)),
        "k": _w((lambda *s: torch.randn(*s, dtype=torch.bfloat16) * 0.8)(B, H, S, D)),
        "v": _w((lambda *s: torch.randn(*s, dtype=torch.bfloat16) * 0.8)(B, H, S, D)),
        "proj": _w((lambda *s: torch.randn(*s, dtype=torch.bfloat16) * 0.8)(M, D)),
    }

def reference(q, k, v, proj):
    B, H, S, D = q.shape
    M = proj.shape[0]
    scale = D ** -0.25
    qs = q * scale
    ks = k * scale
    qw = torch.einsum("bhsd,md->bhsm", qs, proj)
    kw = torch.einsum("bhsd,md->bhsm", ks, proj)
    qn = torch.einsum("bhsd,bhsd->bhs", qs, qs)[..., None] * 0.5
    kn = torch.einsum("bhsd,bhsd->bhs", ks, ks)[..., None] * 0.5
    inv_sqrt_m = M ** -0.5
    phi_q = torch.exp(qw - qn) * inv_sqrt_m
    phi_k = torch.exp(kw - kn) * inv_sqrt_m
    kv = torch.einsum("bhsm,bhsd->bhmd", phi_k, v)
    ksum = torch.einsum("bhsm->bhm", phi_k)
    num = torch.einsum("bhsm,bhmd->bhsd", phi_q, kv)
    den = torch.einsum("bhsm,bhm->bhs", phi_q, ksum)[..., None] + 1e-6
    return num / den
```

```asm
; @launch grid=(256,1,1) block=(512,1,1) lds=157504
.amdgcn_target "amdgcn-amd-amdhsa--gfx950"
.text
.globl standalone__linear_kernel_performer__prompt_kernel
.p2align 8
.type standalone__linear_kernel_performer__prompt_kernel,@function
standalone__linear_kernel_performer__prompt_kernel:
    s_load_dwordx4 s[4:7], s[0:1], 0
    s_load_dwordx4 s[8:11], s[0:1], 16
    s_load_dwordx4 s[12:15], s[0:1], 32
    s_load_dwordx2 s[60:61], s[0:1], 48
    s_cmp_ge_u32 s2, 256
    s_cbranch_scc1 L_end
    v_lshrrev_b32 v1, 6, v0
    v_and_b32 v0, 63, v0
    v_readfirstlane_b32 s44, v1
    s_and_b32 s45, s2, 7
    s_lshr_b32 s47, s2, 6
    s_lshl_b32 s47, s47, 3
    s_or_b32 s45, s45, s47
    s_bfe_u32 s46, s2, 0x30003
    s_lshl_b32 s91, s45, 19
    s_lshr_b32 s65, s46, 1
    s_lshl_b32 s65, s65, 17
    s_or_b32 s65, s91, s65
    s_lshl_b32 s64, s46, 16
    s_or_b32 s91, s91, s64
    s_mov_b32 s49, 1054579418
    s_cmp_lt_u32 s44, 4
    s_cbranch_scc1 L_kv
    s_sub_u32 s53, s44, 4
    v_lshrrev_b32 v2, 4, v0
    v_and_b32 v3, 15, v0
    s_lshl_b32 s48, s53, 12
    v_lshl_add_u32 v7, v2, 8, s48
    v_xor_b32 v8, v2, v3
    v_lshl_add_u32 v4, v8, 4, v7
    v_xor_b32 v5, 64, v4
    v_xor_b32 v6, 128, v4
    v_xor_b32 v9, 192, v4
    v_lshlrev_b32 v8, 1, v2
    v_xor_b32 v8, v8, v3
    v_lshl_add_u32 v10, v8, 4, v7
    v_xor_b32 v11, 128, v10
    s_and_b32 s64, s46, 1
    s_lshl_b32 s64, s64, 14
    s_waitcnt lgkmcnt(0)
    s_add_u32 s16, s6, s65
    s_addc_u32 s17, s7, 0
    s_mov_b32 s18, 131072
    s_mov_b32 s19, 0x00020000
    s_add_u32 m0, s48, 0
    s_mov_b32 s47, 0
    buffer_load_dwordx4 v4, s[16:19], s47 offen offset:0 nt lds
    buffer_load_dwordx4 v5, s[16:19], s47 offen offset:1024 nt lds
    buffer_load_dwordx4 v6, s[16:19], s47 offen offset:2048 nt lds
    buffer_load_dwordx4 v9, s[16:19], s47 offen offset:3072 nt lds
    s_mov_b32 s32, s10
    s_mov_b32 s33, s11
    s_mov_b32 s34, 32768
    s_mov_b32 s35, 0x00020000
    s_add_u32 m0, s48, 123904
    s_add_u32 s47, s64, 0
    buffer_load_dwordx4 v4, s[32:35], s47 offen offset:0 lds
    buffer_load_dwordx4 v5, s[32:35], s47 offen offset:1024 lds
    buffer_load_dwordx4 v6, s[32:35], s47 offen offset:2048 lds
    buffer_load_dwordx4 v9, s[32:35], s47 offen offset:3072 lds
    s_add_u32 m0, s48, 16384
    s_mov_b32 s47, 16384
    buffer_load_dwordx4 v4, s[16:19], s47 offen offset:0 nt lds
    buffer_load_dwordx4 v5, s[16:19], s47 offen offset:1024 nt lds
    buffer_load_dwordx4 v6, s[16:19], s47 offen offset:2048 nt lds
    buffer_load_dwordx4 v9, s[16:19], s47 offen offset:3072 nt lds
    s_xor_b32 s64, s64, 16384
    s_add_u32 s20, s8, s65
    s_addc_u32 s21, s9, 0
    s_mov_b32 s22, 131072
    s_mov_b32 s23, 0x00020000
    s_add_u32 s24, s4, s91
    s_addc_u32 s25, s5, 0
    s_mov_b32 s26, 65536
    s_mov_b32 s27, 0x00020000
    s_add_u32 s28, s12, s91
    s_addc_u32 s29, s13, 0
    s_mov_b32 s30, 65536
    s_mov_b32 s31, 0x00020000
    s_mul_i32 s47, s45, 139264
    s_mov_b32 s40, s14
    s_mov_b32 s41, s15
    s_mov_b32 s42, 256
    s_mov_b32 s43, 0x00020000
    s_add_u32 s36, s60, s47
    s_addc_u32 s37, s61, 0
    s_mov_b32 s38, 139264
    s_mov_b32 s39, 0x00020000
    s_lshl_b32 s12, s46, 2
    s_add_u32 s12, s12, s53
    s_mul_i32 s12, s12, 4352
    s_lshl_b32 s13, s45, 3
    s_getreg_b32 s14, hwreg(HW_REG_XCC_ID, 0, 4)
    s_and_b32 s14, s14, 7
    s_lshl_b32 s14, s14, 2
    s_lshl_b32 s14, 1, s14
    s_mul_i32 s65, s53, 12288
    s_mov_b32 s56, 0
    s_mov_b32 s57, 4096
    s_mov_b32 s58, 8192
    s_mov_b32 s59, 12288
    s_mov_b32 s54, 897988541
    s_mov_b32 s50, 3189258224
    s_mov_b32 s15, 3189258224
    v_xor_b32 v7, v2, v3
    v_lshlrev_b32 v7, 4, v7
    v_lshl_add_u32 v7, v3, 8, v7
    v_add_u32 v8, s48, v7
    v_xor_b32 v28, 0, v8
    v_xor_b32 v29, 64, v8
    v_xor_b32 v30, 128, v8
    v_xor_b32 v31, 192, v8
    v_add_u32 v8, 123904, v7
    v_xor_b32 v224, 0, v8
    v_xor_b32 v225, 64, v8
    v_xor_b32 v226, 128, v8
    v_xor_b32 v227, 192, v8
    v_add_u32 v8, 98304, v7
    v_xor_b32 v228, 0, v8
    v_xor_b32 v229, 64, v8
    v_xor_b32 v230, 128, v8
    v_xor_b32 v231, 192, v8
    v_mov_b32 v14, 3238170575
    v_mov_b32 v15, 3238170575
    v_mov_b32 v24, 157440
    v_mov_b32 v25, 0
    ds_write_b32 v24, v25
    v_lshrrev_b32 v21, 2, v0
    v_and_b32 v12, 3, v0
    v_lshlrev_b32 v12, 6, v12
    v_lshl_add_u32 v12, v21, 8, v12
    v_add_u32 v12, s48, v12
    v_and_b32 v20, 3, v21
    v_lshl_add_u32 v16, v20, 4, v12
    v_xor_b32 v17, 16, v16
    v_xor_b32 v18, 32, v16
    v_xor_b32 v19, 48, v16
    s_lshl_b32 s47, s53, 6
    s_add_u32 s47, s47, 122880
    v_lshl_add_u32 v13, v21, 2, s47
    s_add_u32 m0, s48, 32768
    s_mov_b32 s47, 32768
    buffer_load_dwordx4 v4, s[16:19], s47 offen offset:0 nt lds
    buffer_load_dwordx4 v5, s[16:19], s47 offen offset:1024 nt lds
    buffer_load_dwordx4 v6, s[16:19], s47 offen offset:2048 nt lds
    buffer_load_dwordx4 v9, s[16:19], s47 offen offset:3072 nt lds
    s_waitcnt vmcnt(12)
    ds_read_b128 v[208:211], v16 offset:0
    ds_read_b128 v[212:215], v17 offset:0
    ds_read_b128 v[216:219], v18 offset:0
    ds_read_b128 v[220:223], v19 offset:0
    s_waitcnt lgkmcnt(3)
    v_dot2_f32_bf16 v20, v208, v208, 0
    v_dot2_f32_bf16 v21, v209, v209, 0
    s_nop 1
    v_dot2c_f32_bf16 v20, v210, v210
    v_dot2c_f32_bf16 v21, v211, v211
    s_waitcnt lgkmcnt(2)
    v_dot2c_f32_bf16 v20, v212, v212
    v_dot2c_f32_bf16 v21, v213, v213
    v_dot2c_f32_bf16 v20, v214, v214
    v_dot2c_f32_bf16 v21, v215, v215
    s_waitcnt lgkmcnt(1)
    v_dot2c_f32_bf16 v20, v216, v216
    v_dot2c_f32_bf16 v21, v217, v217
    v_dot2c_f32_bf16 v20, v218, v218
    v_dot2c_f32_bf16 v21, v219, v219
    s_waitcnt lgkmcnt(0)
    v_dot2c_f32_bf16 v20, v220, v220
    v_dot2c_f32_bf16 v21, v221, v221
    v_dot2c_f32_bf16 v20, v222, v222
    v_dot2c_f32_bf16 v21, v223, v223
    s_nop 2
    v_add_f32 v20, v20, v21
    s_nop 1
    v_add_f32 v20, v20, v20 quad_perm:[1,0,3,2]
    s_nop 1
    v_add_f32 v20, v20, v20 quad_perm:[2,3,0,1]
    v_fma_f32 v12, v20, s15, v15
    ds_write_b32 v13, v12 offset:0
    s_waitcnt vmcnt(8)
    s_waitcnt lgkmcnt(0)
    s_barrier
    s_add_u32 m0, s48, 98304
    s_add_u32 s47, s64, 0
    buffer_load_dwordx4 v4, s[32:35], s47 offen offset:0 lds
    buffer_load_dwordx4 v5, s[32:35], s47 offen offset:1024 lds
    buffer_load_dwordx4 v6, s[32:35], s47 offen offset:2048 lds
    buffer_load_dwordx4 v9, s[32:35], s47 offen offset:3072 lds
    s_add_u32 m0, s48, 65536
    s_mov_b32 s47, 0
    buffer_load_dwordx4 v10, s[20:23], s47 offen offset:0 nt lds
    buffer_load_dwordx4 v11, s[20:23], s47 offen offset:1024 nt lds
    buffer_load_dwordx4 v10, s[20:23], s47 offen offset:2048 nt lds
    buffer_load_dwordx4 v11, s[20:23], s47 offen offset:3072 nt lds
    ds_read_b128 v[32:35], v224 offset:0
    ds_read_b128 v[36:39], v225 offset:0
    ds_read_b128 v[40:43], v226 offset:0
    ds_read_b128 v[44:47], v227 offset:0
    ds_read_b128 v[48:51], v224 offset:4096
    ds_read_b128 v[52:55], v225 offset:4096
    ds_read_b128 v[56:59], v226 offset:4096
    ds_read_b128 v[60:63], v227 offset:4096
    ds_read_b128 v[64:67], v224 offset:8192
    ds_read_b128 v[68:71], v225 offset:8192
    ds_read_b128 v[72:75], v226 offset:8192
    ds_read_b128 v[76:79], v227 offset:8192
    ds_read_b128 v[80:83], v224 offset:12288
    ds_read_b128 v[84:87], v225 offset:12288
    ds_read_b128 v[88:91], v226 offset:12288
    ds_read_b128 v[92:95], v227 offset:12288
    s_waitcnt vmcnt(12)
    ds_read_b128 v[208:211], v16 offset:16384
    ds_read_b128 v[212:215], v17 offset:16384
    ds_read_b128 v[216:219], v18 offset:16384
    ds_read_b128 v[220:223], v19 offset:16384
    s_add_u32 m0, s48, 49152
    s_mov_b32 s47, 49152
    buffer_load_dwordx4 v4, s[16:19], s47 offen offset:0 nt lds
    buffer_load_dwordx4 v5, s[16:19], s47 offen offset:1024 nt lds
    buffer_load_dwordx4 v6, s[16:19], s47 offen offset:2048 nt lds
    buffer_load_dwordx4 v9, s[16:19], s47 offen offset:3072 nt lds
    s_add_u32 m0, s48, 81920
    s_mov_b32 s47, 16384
    buffer_load_dwordx4 v10, s[20:23], s47 offen offset:0 nt lds
    buffer_load_dwordx4 v11, s[20:23], s47 offen offset:1024 nt lds
    buffer_load_dwordx4 v10, s[20:23], s47 offen offset:2048 nt lds
    buffer_load_dwordx4 v11, s[20:23], s47 offen offset:3072 nt lds
    v_mov_b32 v176, -1
    v_mov_b32 v177, -1
    v_mov_b32 v178, -1
    v_mov_b32 v179, -1
    v_lshlrev_b32 v180, 6, v0
    v_and_b32 v181, 0xff, v180
    v_lshlrev_b32 v182, 4, v0
    v_lshlrev_b32 v183, 2, v0
    buffer_load_dword v184, v180, s[36:39], s12 offen offset:256
    buffer_load_dword v185, v181, s[36:39], s12 offen
    buffer_store_dwordx4 v[176:179], v182, s[36:39], s12 offen offset:256
    buffer_store_dwordx4 v[176:179], v182, s[36:39], s12 offen offset:1280
    buffer_store_dwordx4 v[176:179], v182, s[36:39], s12 offen offset:2304
    buffer_store_dwordx4 v[176:179], v182, s[36:39], s12 offen offset:3328
    buffer_store_dword v176, v183, s[36:39], s12 offen
    s_waitcnt lgkmcnt(3)
    v_dot2_f32_bf16 v20, v208, v208, 0
    v_dot2_f32_bf16 v21, v209, v209, 0
    s_nop 1
    v_dot2c_f32_bf16 v20, v210, v210
    v_dot2c_f32_bf16 v21, v211, v211
    s_waitcnt lgkmcnt(2)
    v_dot2c_f32_bf16 v20, v212, v212
    v_dot2c_f32_bf16 v21, v213, v213
    v_dot2c_f32_bf16 v20, v214, v214
    v_dot2c_f32_bf16 v21, v215, v215
    s_waitcnt lgkmcnt(1)
    v_dot2c_f32_bf16 v20, v216, v216
    v_dot2c_f32_bf16 v21, v217, v217
    v_dot2c_f32_bf16 v20, v218, v218
    v_dot2c_f32_bf16 v21, v219, v219
    s_waitcnt lgkmcnt(0)
    v_dot2c_f32_bf16 v20, v220, v220
    v_dot2c_f32_bf16 v21, v221, v221
    v_dot2c_f32_bf16 v20, v222, v222
    v_dot2c_f32_bf16 v21, v223, v223
    s_nop 2
    v_add_f32 v20, v20, v21
    s_nop 1
    v_add_f32 v20, v20, v20 quad_perm:[1,0,3,2]
    s_nop 1
    v_add_f32 v20, v20, v20 quad_perm:[2,3,0,1]
    v_fma_f32 v12, v20, s15, v15
    ds_write_b32 v13, v12 offset:256
    s_waitcnt vmcnt(19)
    s_waitcnt lgkmcnt(0)
    s_barrier
    s_add_u32 m0, s48, 123904
    s_mov_b32 s47, 32768
    buffer_load_dwordx4 v10, s[20:23], s47 offen offset:0 nt lds
    buffer_load_dwordx4 v11, s[20:23], s47 offen offset:1024 nt lds
    buffer_load_dwordx4 v10, s[20:23], s47 offen offset:2048 nt lds
    buffer_load_dwordx4 v11, s[20:23], s47 offen offset:3072 nt lds
    ds_read_b128 v[96:99], v228 offset:0
    ds_read_b128 v[100:103], v229 offset:0
    ds_read_b128 v[104:107], v230 offset:0
    ds_read_b128 v[108:111], v231 offset:0
    ds_read_b128 v[112:115], v228 offset:4096
    ds_read_b128 v[116:119], v229 offset:4096
    ds_read_b128 v[120:123], v230 offset:4096
    ds_read_b128 v[124:127], v231 offset:4096
    ds_read_b128 v[128:131], v228 offset:8192
    ds_read_b128 v[132:135], v229 offset:8192
    ds_read_b128 v[136:139], v230 offset:8192
    ds_read_b128 v[140:143], v231 offset:8192
    ds_read_b128 v[144:147], v228 offset:12288
    ds_read_b128 v[148:151], v229 offset:12288
    ds_read_b128 v[152:155], v230 offset:12288
    ds_read_b128 v[156:159], v231 offset:12288
    s_waitcnt vmcnt(27)
    ds_read_b128 v[208:211], v16 offset:32768
    ds_read_b128 v[212:215], v17 offset:32768
    ds_read_b128 v[216:219], v18 offset:32768
    ds_read_b128 v[220:223], v19 offset:32768
    s_add_u32 m0, s48, 0
    s_mov_b32 s47, 65536
    buffer_load_dwordx4 v4, s[16:19], s47 offen offset:0 nt lds
    buffer_load_dwordx4 v5, s[16:19], s47 offen offset:1024 nt lds
    buffer_load_dwordx4 v6, s[16:19], s47 offen offset:2048 nt lds
    buffer_load_dwordx4 v9, s[16:19], s47 offen offset:3072 nt lds
    s_waitcnt lgkmcnt(3)
    v_dot2_f32_bf16 v20, v208, v208, 0
    v_dot2_f32_bf16 v21, v209, v209, 0
    s_nop 1
    v_dot2c_f32_bf16 v20, v210, v210
    v_dot2c_f32_bf16 v21, v211, v211
    s_waitcnt lgkmcnt(2)
    v_dot2c_f32_bf16 v20, v212, v212
    v_dot2c_f32_bf16 v21, v213, v213
    v_dot2c_f32_bf16 v20, v214, v214
    v_dot2c_f32_bf16 v21, v215, v215
    s_waitcnt lgkmcnt(1)
    v_dot2c_f32_bf16 v20, v216, v216
    v_dot2c_f32_bf16 v21, v217, v217
    v_dot2c_f32_bf16 v20, v218, v218
    v_dot2c_f32_bf16 v21, v219, v219
    s_waitcnt lgkmcnt(0)
    v_dot2c_f32_bf16 v20, v220, v220
    v_dot2c_f32_bf16 v21, v221, v221
    v_dot2c_f32_bf16 v20, v222, v222
    v_dot2c_f32_bf16 v21, v223, v223
    s_nop 2
    v_add_f32 v20, v20, v21
    s_nop 1
    v_add_f32 v20, v20, v20 quad_perm:[1,0,3,2]
    s_nop 1
    v_add_f32 v20, v20, v20 quad_perm:[2,3,0,1]
    v_fma_f32 v12, v20, s15, v15
    ds_write_b32 v13, v12 offset:0
    s_waitcnt vmcnt(23)
    s_waitcnt lgkmcnt(0)
    s_barrier
    s_add_u32 m0, s48, 98304
    s_mov_b32 s47, 49152
    buffer_load_dwordx4 v10, s[20:23], s47 offen offset:0 nt lds
    buffer_load_dwordx4 v11, s[20:23], s47 offen offset:1024 nt lds
    buffer_load_dwordx4 v10, s[20:23], s47 offen offset:2048 nt lds
    buffer_load_dwordx4 v11, s[20:23], s47 offen offset:3072 nt lds
    s_waitcnt vmcnt(23)
    ds_read_b128 v[208:211], v16 offset:49152
    ds_read_b128 v[212:215], v17 offset:49152
    ds_read_b128 v[216:219], v18 offset:49152
    ds_read_b128 v[220:223], v19 offset:49152
    s_add_u32 m0, s48, 16384
    s_mov_b32 s47, 81920
    buffer_load_dwordx4 v4, s[16:19], s47 offen offset:0 nt lds
    buffer_load_dwordx4 v5, s[16:19], s47 offen offset:1024 nt lds
    buffer_load_dwordx4 v6, s[16:19], s47 offen offset:2048 nt lds
    buffer_load_dwordx4 v9, s[16:19], s47 offen offset:3072 nt lds
    s_waitcnt lgkmcnt(3)
    v_dot2_f32_bf16 v20, v208, v208, 0
    v_dot2_f32_bf16 v21, v209, v209, 0
    s_nop 1
    v_dot2c_f32_bf16 v20, v210, v210
    v_dot2c_f32_bf16 v21, v211, v211
    s_waitcnt lgkmcnt(2)
    v_dot2c_f32_bf16 v20, v212, v212
    v_dot2c_f32_bf16 v21, v213, v213
    v_dot2c_f32_bf16 v20, v214, v214
    v_dot2c_f32_bf16 v21, v215, v215
    s_waitcnt lgkmcnt(1)
    v_dot2c_f32_bf16 v20, v216, v216
    v_dot2c_f32_bf16 v21, v217, v217
    v_dot2c_f32_bf16 v20, v218, v218
    v_dot2c_f32_bf16 v21, v219, v219
    s_waitcnt lgkmcnt(0)
    v_dot2c_f32_bf16 v20, v220, v220
    v_dot2c_f32_bf16 v21, v221, v221
    v_dot2c_f32_bf16 v20, v222, v222
    v_dot2c_f32_bf16 v21, v223, v223
    s_nop 2
    v_add_f32 v20, v20, v21
    s_nop 1
    v_add_f32 v20, v20, v20 quad_perm:[1,0,3,2]
    s_nop 1
    v_add_f32 v20, v20, v20 quad_perm:[2,3,0,1]
    v_fma_f32 v12, v20, s15, v15
    ds_write_b32 v13, v12 offset:256
    s_waitcnt vmcnt(16)
    s_waitcnt lgkmcnt(0)
    s_barrier
    s_cmp_eq_u32 s53, 0
    s_cselect_b32 s47, s13, 0x1000
    v_mov_b32 v186, s14
    v_mov_b32 v187, 0
    s_mov_b64 exec, 1
    buffer_atomic_add v186, v187, s[40:43], s47 offen sc1
    s_mov_b64 exec, -1
    s_add_u32 m0, s48, 65536
    s_mov_b32 s47, 65536
    buffer_load_dwordx4 v10, s[20:23], s47 offen offset:0 nt lds
    buffer_load_dwordx4 v11, s[20:23], s47 offen offset:1024 nt lds
    buffer_load_dwordx4 v10, s[20:23], s47 offen offset:2048 nt lds
    buffer_load_dwordx4 v11, s[20:23], s47 offen offset:3072 nt lds
    s_waitcnt vmcnt(13)
    ds_read_b128 v[208:211], v16 offset:0
    ds_read_b128 v[212:215], v17 offset:0
    ds_read_b128 v[216:219], v18 offset:0
    ds_read_b128 v[220:223], v19 offset:0
    s_add_u32 m0, s48, 32768
    s_mov_b32 s47, 98304
    buffer_load_dwordx4 v4, s[16:19], s47 offen offset:0 nt lds
    buffer_load_dwordx4 v5, s[16:19], s47 offen offset:1024 nt lds
    buffer_load_dwordx4 v6, s[16:19], s47 offen offset:2048 nt lds
    buffer_load_dwordx4 v9, s[16:19], s47 offen offset:3072 nt lds
    s_waitcnt lgkmcnt(3)
    v_dot2_f32_bf16 v20, v208, v208, 0
    v_dot2_f32_bf16 v21, v209, v209, 0
    s_nop 1
    v_dot2c_f32_bf16 v20, v210, v210
    v_dot2c_f32_bf16 v21, v211, v211
    s_waitcnt lgkmcnt(2)
    v_dot2c_f32_bf16 v20, v212, v212
    v_dot2c_f32_bf16 v21, v213, v213
    v_dot2c_f32_bf16 v20, v214, v214
    v_dot2c_f32_bf16 v21, v215, v215
    s_waitcnt lgkmcnt(1)
    v_dot2c_f32_bf16 v20, v216, v216
    v_dot2c_f32_bf16 v21, v217, v217
    v_dot2c_f32_bf16 v20, v218, v218
    v_dot2c_f32_bf16 v21, v219, v219
    s_waitcnt lgkmcnt(0)
    v_dot2c_f32_bf16 v20, v220, v220
    v_dot2c_f32_bf16 v21, v221, v221
    v_dot2c_f32_bf16 v20, v222, v222
    v_dot2c_f32_bf16 v21, v223, v223
    s_nop 2
    v_add_f32 v20, v20, v21
    s_nop 1
    v_add_f32 v20, v20, v20 quad_perm:[1,0,3,2]
    s_nop 1
    v_add_f32 v20, v20, v20 quad_perm:[2,3,0,1]
    v_fma_f32 v12, v20, s15, v15
    ds_write_b32 v13, v12 offset:0
    s_waitcnt vmcnt(21)
    s_waitcnt lgkmcnt(0)
    s_barrier
    s_add_u32 m0, s48, 81920
    s_mov_b32 s47, 81920
    buffer_load_dwordx4 v10, s[20:23], s47 offen offset:0 nt lds
    buffer_load_dwordx4 v11, s[20:23], s47 offen offset:1024 nt lds
    buffer_load_dwordx4 v10, s[20:23], s47 offen offset:2048 nt lds
    buffer_load_dwordx4 v11, s[20:23], s47 offen offset:3072 nt lds
    s_waitcnt vmcnt(13)
    ds_read_b128 v[208:211], v16 offset:16384
    ds_read_b128 v[212:215], v17 offset:16384
    ds_read_b128 v[216:219], v18 offset:16384
    ds_read_b128 v[220:223], v19 offset:16384
    s_add_u32 m0, s48, 49152
    s_mov_b32 s47, 114688
    buffer_load_dwordx4 v4, s[16:19], s47 offen offset:0 nt lds
    buffer_load_dwordx4 v5, s[16:19], s47 offen offset:1024 nt lds
    buffer_load_dwordx4 v6, s[16:19], s47 offen offset:2048 nt lds
    buffer_load_dwordx4 v9, s[16:19], s47 offen offset:3072 nt lds
    s_waitcnt lgkmcnt(3)
    v_dot2_f32_bf16 v20, v208, v208, 0
    v_dot2_f32_bf16 v21, v209, v209, 0
    s_nop 1
    v_dot2c_f32_bf16 v20, v210, v210
    v_dot2c_f32_bf16 v21, v211, v211
    s_waitcnt lgkmcnt(2)
    v_dot2c_f32_bf16 v20, v212, v212
    v_dot2c_f32_bf16 v21, v213, v213
    v_dot2c_f32_bf16 v20, v214, v214
    v_dot2c_f32_bf16 v21, v215, v215
    s_waitcnt lgkmcnt(1)
    v_dot2c_f32_bf16 v20, v216, v216
    v_dot2c_f32_bf16 v21, v217, v217
    v_dot2c_f32_bf16 v20, v218, v218
    v_dot2c_f32_bf16 v21, v219, v219
    s_waitcnt lgkmcnt(0)
    v_dot2c_f32_bf16 v20, v220, v220
    v_dot2c_f32_bf16 v21, v221, v221
    v_dot2c_f32_bf16 v20, v222, v222
    v_dot2c_f32_bf16 v21, v223, v223
    s_nop 2
    v_add_f32 v20, v20, v21
    s_nop 1
    v_add_f32 v20, v20, v20 quad_perm:[1,0,3,2]
    s_nop 1
    v_add_f32 v20, v20, v20 quad_perm:[2,3,0,1]
    v_fma_f32 v12, v20, s15, v15
    ds_write_b32 v13, v12 offset:256
    s_waitcnt vmcnt(21)
    s_waitcnt lgkmcnt(0)
    s_barrier
    s_add_u32 m0, s48, 123904
    s_mov_b32 s47, 98304
    buffer_load_dwordx4 v10, s[20:23], s47 offen offset:0 nt lds
    buffer_load_dwordx4 v11, s[20:23], s47 offen offset:1024 nt lds
    buffer_load_dwordx4 v10, s[20:23], s47 offen offset:2048 nt lds
    buffer_load_dwordx4 v11, s[20:23], s47 offen offset:3072 nt lds
    s_waitcnt vmcnt(12)
    ds_read_b128 v[208:211], v16 offset:32768
    ds_read_b128 v[212:215], v17 offset:32768
    ds_read_b128 v[216:219], v18 offset:32768
    ds_read_b128 v[220:223], v19 offset:32768
    s_waitcnt lgkmcnt(3)
    v_dot2_f32_bf16 v20, v208, v208, 0
    v_dot2_f32_bf16 v21, v209, v209, 0
    s_nop 1
    v_dot2c_f32_bf16 v20, v210, v210
    v_dot2c_f32_bf16 v21, v211, v211
    s_waitcnt lgkmcnt(2)
    v_dot2c_f32_bf16 v20, v212, v212
    v_dot2c_f32_bf16 v21, v213, v213
    v_dot2c_f32_bf16 v20, v214, v214
    v_dot2c_f32_bf16 v21, v215, v215
    s_waitcnt lgkmcnt(1)
    v_dot2c_f32_bf16 v20, v216, v216
    v_dot2c_f32_bf16 v21, v217, v217
    v_dot2c_f32_bf16 v20, v218, v218
    v_dot2c_f32_bf16 v21, v219, v219
    s_waitcnt lgkmcnt(0)
    v_dot2c_f32_bf16 v20, v220, v220
    v_dot2c_f32_bf16 v21, v221, v221
    v_dot2c_f32_bf16 v20, v222, v222
    v_dot2c_f32_bf16 v21, v223, v223
    s_nop 2
    v_add_f32 v20, v20, v21
    s_nop 1
    v_add_f32 v20, v20, v20 quad_perm:[1,0,3,2]
    s_nop 1
    v_add_f32 v20, v20, v20 quad_perm:[2,3,0,1]
    v_fma_f32 v12, v20, s15, v15
    ds_write_b32 v13, v12 offset:0
    s_waitcnt vmcnt(16)
    s_waitcnt lgkmcnt(0)
    s_barrier
    v_mov_b32 v187, 0
    buffer_load_dword v188, v187, s[40:43], s13 offen sc1
    s_add_u32 m0, s48, 98304
    s_mov_b32 s47, 114688
    buffer_load_dwordx4 v10, s[20:23], s47 offen offset:0 nt lds
    buffer_load_dwordx4 v11, s[20:23], s47 offen offset:1024 nt lds
    buffer_load_dwordx4 v10, s[20:23], s47 offen offset:2048 nt lds
    buffer_load_dwordx4 v11, s[20:23], s47 offen offset:3072 nt lds
    s_waitcnt vmcnt(9)
    ds_read_b128 v[208:211], v16 offset:49152
    ds_read_b128 v[212:215], v17 offset:49152
    ds_read_b128 v[216:219], v18 offset:49152
    ds_read_b128 v[220:223], v19 offset:49152
    s_add_u32 m0, s48, 0
    s_add_u32 s47, s65, 0
    buffer_load_dwordx4 v4, s[24:27], s47 offen offset:0 nt lds
    buffer_load_dwordx4 v5, s[24:27], s47 offen offset:1024 nt lds
    buffer_load_dwordx4 v6, s[24:27], s47 offen offset:2048 nt lds
    buffer_load_dwordx4 v9, s[24:27], s47 offen offset:3072 nt lds
    s_waitcnt lgkmcnt(3)
    v_dot2_f32_bf16 v20, v208, v208, 0
    v_dot2_f32_bf16 v21, v209, v209, 0
    s_nop 1
    v_dot2c_f32_bf16 v20, v210, v210
    v_dot2c_f32_bf16 v21, v211, v211
    s_waitcnt lgkmcnt(2)
    v_dot2c_f32_bf16 v20, v212, v212
    v_dot2c_f32_bf16 v21, v213, v213
    v_dot2c_f32_bf16 v20, v214, v214
    v_dot2c_f32_bf16 v21, v215, v215
    s_waitcnt lgkmcnt(1)
    v_dot2c_f32_bf16 v20, v216, v216
    v_dot2c_f32_bf16 v21, v217, v217
    v_dot2c_f32_bf16 v20, v218, v218
    v_dot2c_f32_bf16 v21, v219, v219
    s_waitcnt lgkmcnt(0)
    v_dot2c_f32_bf16 v20, v220, v220
    v_dot2c_f32_bf16 v21, v221, v221
    v_dot2c_f32_bf16 v20, v222, v222
    v_dot2c_f32_bf16 v21, v223, v223
    s_nop 2
    v_add_f32 v20, v20, v21
    s_nop 1
    v_add_f32 v20, v20, v20 quad_perm:[1,0,3,2]
    s_nop 1
    v_add_f32 v20, v20, v20 quad_perm:[2,3,0,1]
    v_fma_f32 v12, v20, s15, v15
    ds_write_b32 v13, v12 offset:256
    s_waitcnt vmcnt(17)
    s_waitcnt lgkmcnt(0)
    s_barrier
    s_add_u32 m0, s48, 16384
    s_add_u32 s47, s65, 4096
    buffer_load_dwordx4 v4, s[24:27], s47 offen offset:0 nt lds
    buffer_load_dwordx4 v5, s[24:27], s47 offen offset:1024 nt lds
    buffer_load_dwordx4 v6, s[24:27], s47 offen offset:2048 nt lds
    buffer_load_dwordx4 v9, s[24:27], s47 offen offset:3072 nt lds
    s_waitcnt vmcnt(12)
    ds_write_b32 v24, v188 offset:4
    s_waitcnt lgkmcnt(0)
    s_barrier
    s_waitcnt vmcnt(8)
    s_waitcnt lgkmcnt(0)
    s_barrier
    s_add_u32 m0, s48, 32768
    s_add_u32 s47, s65, 8192
    buffer_load_dwordx4 v4, s[24:27], s47 offen offset:0 nt lds
    buffer_load_dwordx4 v5, s[24:27], s47 offen offset:1024 nt lds
    buffer_load_dwordx4 v6, s[24:27], s47 offen offset:2048 nt lds
    buffer_load_dwordx4 v9, s[24:27], s47 offen offset:3072 nt lds
    s_setprio 0
    s_waitcnt vmcnt(8)
    ds_read_b128 v[224:227], v28 offset:0
    ds_read_b128 v[228:231], v29 offset:0
    ds_read_b128 v[232:235], v30 offset:0
    ds_read_b128 v[236:239], v31 offset:0
    v_mov_b32 v26, 0
    v_mov_b32 v27, 0
    s_waitcnt lgkmcnt(3)
    v_dot2c_f32_bf16 v26, v224, v224
    v_dot2c_f32_bf16 v27, v225, v225
    v_dot2c_f32_bf16 v26, v226, v226
    v_dot2c_f32_bf16 v27, v227, v227
    s_waitcnt lgkmcnt(2)
    v_dot2c_f32_bf16 v26, v228, v228
    v_dot2c_f32_bf16 v27, v229, v229
    v_dot2c_f32_bf16 v26, v230, v230
    v_dot2c_f32_bf16 v27, v231, v231
    s_waitcnt lgkmcnt(1)
    v_dot2c_f32_bf16 v26, v232, v232
    v_dot2c_f32_bf16 v27, v233, v233
    v_dot2c_f32_bf16 v26, v234, v234
    v_dot2c_f32_bf16 v27, v235, v235
    s_waitcnt lgkmcnt(0)
    v_dot2c_f32_bf16 v26, v236, v236
    v_dot2c_f32_bf16 v27, v237, v237
    v_dot2c_f32_bf16 v26, v238, v238
    v_dot2c_f32_bf16 v27, v239, v239
    s_nop 2
    v_add_f32 v26, v26, v27
    v_mov_b32 v27, v26
    s_nop 1
    v_permlane16_swap_b32 v26, v27
    v_add_f32 v26, v26, v27
    v_mov_b32 v27, v26
    s_nop 1
    v_permlane32_swap_b32 v26, v27
    v_add_f32 v26, v26, v27
    v_fma_f32 v20, v26, s50, v14
    v_fma_f32 v21, v26, s50, v14
    v_fma_f32 v22, v26, s50, v14
    v_fma_f32 v23, v26, s50, v14
    s_nop 1
    v_mfma_f32_16x16x32_bf16 v[240:243], v[32:35], v[224:227], v[20:23]
    v_mfma_f32_16x16x32_bf16 v[244:247], v[48:51], v[224:227], v[20:23]
    v_mfma_f32_16x16x32_bf16 v[240:243], v[36:39], v[228:231], v[240:243]
    v_mfma_f32_16x16x32_bf16 v[244:247], v[52:55], v[228:231], v[244:247]
    v_mfma_f32_16x16x32_bf16 v[240:243], v[40:43], v[232:235], v[240:243]
    v_mfma_f32_16x16x32_bf16 v[244:247], v[56:59], v[232:235], v[244:247]
    v_mfma_f32_16x16x32_bf16 v[240:243], v[44:47], v[236:239], v[240:243]
    v_mfma_f32_16x16x32_bf16 v[244:247], v[60:63], v[236:239], v[244:247]
    v_mfma_f32_16x16x32_bf16 v[248:251], v[64:67], v[224:227], v[20:23]
    s_nop 5
    v_mul_f32 v240, s49, v240
    v_mul_f32 v241, s49, v241
    v_mfma_f32_16x16x32_bf16 v[252:255], v[80:83], v[224:227], v[20:23]
    v_exp_f32 v240, v240
    v_exp_f32 v241, v241
    v_mul_f32 v242, s49, v242
    v_mfma_f32_16x16x32_bf16 v[248:251], v[68:71], v[228:231], v[248:251]
    v_mul_f32 v243, s49, v243
    v_cvt_pk_bf16_f32 v160, v240, v241
    v_mfma_f32_16x16x32_bf16 v[252:255], v[84:87], v[228:231], v[252:255]
    v_exp_f32 v242, v242
    v_exp_f32 v243, v243
    v_mul_f32 v244, s49, v244
    v_mfma_f32_16x16x32_bf16 v[248:251], v[72:75], v[232:235], v[248:251]
    v_mul_f32 v245, s49, v245
    v_cvt_pk_bf16_f32 v161, v242, v243
    v_mfma_f32_16x16x32_bf16 v[252:255], v[88:91], v[232:235], v[252:255]
    v_exp_f32 v244, v244
    v_exp_f32 v245, v245
    v_mul_f32 v246, s49, v246
    v_mfma_f32_16x16x32_bf16 v[248:251], v[76:79], v[236:239], v[248:251]
    v_mul_f32 v247, s49, v247
    v_cvt_pk_bf16_f32 v162, v244, v245
    v_mfma_f32_16x16x32_bf16 v[252:255], v[92:95], v[236:239], v[252:255]
    v_exp_f32 v246, v246
    v_exp_f32 v247, v247
    s_nop 0
    v_cvt_pk_bf16_f32 v163, v246, v247
    v_mfma_f32_16x16x32_bf16 v[240:243], v[96:99], v[224:227], v[20:23]
    v_mul_f32 v248, s49, v248
    v_mul_f32 v249, s49, v249
    v_mfma_f32_16x16x32_bf16 v[244:247], v[112:115], v[224:227], v[20:23]
    v_exp_f32 v248, v248
    v_exp_f32 v249, v249
    v_mul_f32 v250, s49, v250
    v_mfma_f32_16x16x32_bf16 v[240:243], v[100:103], v[228:231], v[240:243]
    v_mul_f32 v251, s49, v251
    v_cvt_pk_bf16_f32 v164, v248, v249
    v_mfma_f32_16x16x32_bf16 v[244:247], v[116:119], v[228:231], v[244:247]
    v_exp_f32 v250, v250
    v_exp_f32 v251, v251
    v_mul_f32 v252, s49, v252
    v_mfma_f32_16x16x32_bf16 v[240:243], v[104:107], v[232:235], v[240:243]
    v_mul_f32 v253, s49, v253
    v_cvt_pk_bf16_f32 v165, v250, v251
    v_mfma_f32_16x16x32_bf16 v[244:247], v[120:123], v[232:235], v[244:247]
    v_exp_f32 v252, v252
    v_exp_f32 v253, v253
    v_mul_f32 v254, s49, v254
    v_mfma_f32_16x16x32_bf16 v[240:243], v[108:111], v[236:239], v[240:243]
    v_mul_f32 v255, s49, v255
    v_cvt_pk_bf16_f32 v166, v252, v253
    v_mfma_f32_16x16x32_bf16 v[244:247], v[124:127], v[236:239], v[244:247]
    v_exp_f32 v254, v254
    v_exp_f32 v255, v255
    s_nop 0
    v_cvt_pk_bf16_f32 v167, v254, v255
    v_mfma_f32_16x16x32_bf16 v[248:251], v[128:131], v[224:227], v[20:23]
    v_mul_f32 v240, s49, v240
    v_mul_f32 v241, s49, v241
    v_mfma_f32_16x16x32_bf16 v[252:255], v[144:147], v[224:227], v[20:23]
    v_exp_f32 v240, v240
    v_exp_f32 v241, v241
    v_mul_f32 v242, s49, v242
    v_mfma_f32_16x16x32_bf16 v[248:251], v[132:135], v[228:231], v[248:251]
    v_mul_f32 v243, s49, v243
    v_cvt_pk_bf16_f32 v168, v240, v241
    v_mfma_f32_16x16x32_bf16 v[252:255], v[148:151], v[228:231], v[252:255]
    v_exp_f32 v242, v242
    v_exp_f32 v243, v243
    v_mul_f32 v244, s49, v244
    v_mfma_f32_16x16x32_bf16 v[248:251], v[136:139], v[232:235], v[248:251]
    v_mul_f32 v245, s49, v245
    v_cvt_pk_bf16_f32 v169, v242, v243
    v_mfma_f32_16x16x32_bf16 v[252:255], v[152:155], v[232:235], v[252:255]
    v_exp_f32 v244, v244
    v_exp_f32 v245, v245
    v_mul_f32 v246, s49, v246
    v_mfma_f32_16x16x32_bf16 v[248:251], v[140:143], v[236:239], v[248:251]
    v_mul_f32 v247, s49, v247
    v_cvt_pk_bf16_f32 v170, v244, v245
    v_mfma_f32_16x16x32_bf16 v[252:255], v[156:159], v[236:239], v[252:255]
    v_exp_f32 v246, v246
    v_exp_f32 v247, v247
    s_nop 0
    v_cvt_pk_bf16_f32 v171, v246, v247
    s_waitcnt vmcnt(4)
    ds_read_b128 v[224:227], v28 offset:16384
    ds_read_b128 v[228:231], v29 offset:16384
    ds_read_b128 v[232:235], v30 offset:16384
    ds_read_b128 v[236:239], v31 offset:16384
    v_mul_f32 v248, s49, v248
    v_mul_f32 v249, s49, v249
    v_exp_f32 v248, v248
    v_exp_f32 v249, v249
    v_mul_f32 v250, s49, v250
    v_mul_f32 v251, s49, v251
    v_cvt_pk_bf16_f32 v172, v248, v249
    v_exp_f32 v250, v250
    v_exp_f32 v251, v251
    v_mul_f32 v252, s49, v252
    v_mul_f32 v253, s49, v253
    v_cvt_pk_bf16_f32 v173, v250, v251
    v_exp_f32 v252, v252
    v_exp_f32 v253, v253
    v_mul_f32 v254, s49, v254
    v_mul_f32 v255, s49, v255
    v_cvt_pk_bf16_f32 v174, v252, v253
    v_exp_f32 v254, v254
    v_exp_f32 v255, v255
    s_nop 0
    v_cvt_pk_bf16_f32 v175, v254, v255
    v_mov_b32 v26, 0
    v_mov_b32 v27, 0
    s_waitcnt lgkmcnt(3)
    v_dot2c_f32_bf16 v26, v224, v224
    v_dot2c_f32_bf16 v27, v225, v225
    v_dot2c_f32_bf16 v26, v226, v226
    v_dot2c_f32_bf16 v27, v227, v227
    s_waitcnt lgkmcnt(2)
    v_dot2c_f32_bf16 v26, v228, v228
    v_dot2c_f32_bf16 v27, v229, v229
    v_dot2c_f32_bf16 v26, v230, v230
    v_dot2c_f32_bf16 v27, v231, v231
    s_waitcnt lgkmcnt(1)
    v_dot2c_f32_bf16 v26, v232, v232
    v_dot2c_f32_bf16 v27, v233, v233
    v_dot2c_f32_bf16 v26, v234, v234
    v_dot2c_f32_bf16 v27, v235, v235
    s_waitcnt lgkmcnt(0)
    v_dot2c_f32_bf16 v26, v236, v236
    v_dot2c_f32_bf16 v27, v237, v237
    v_dot2c_f32_bf16 v26, v238, v238
    v_dot2c_f32_bf16 v27, v239, v239
    s_nop 2
    v_add_f32 v26, v26, v27
    v_mov_b32 v27, v26
    s_nop 1
    v_permlane16_swap_b32 v26, v27
    v_add_f32 v26, v26, v27
    v_mov_b32 v27, v26
    s_nop 1
    v_permlane32_swap_b32 v26, v27
    v_add_f32 v26, v26, v27
    v_fma_f32 v20, v26, s50, v14
    v_fma_f32 v21, v26, s50, v14
    v_fma_f32 v22, v26, s50, v14
    v_fma_f32 v23, v26, s50, v14
    s_nop 1
    v_mfma_f32_16x16x32_bf16 v[240:243], v[32:35], v[224:227], v[20:23]
    v_mfma_f32_16x16x32_bf16 v[244:247], v[48:51], v[224:227], v[20:23]
    v_mfma_f32_16x16x32_bf16 v[240:243], v[36:39], v[228:231], v[240:243]
    v_mfma_f32_16x16x32_bf16 v[244:247], v[52:55], v[228:231], v[244:247]
    v_mfma_f32_16x16x32_bf16 v[240:243], v[40:43], v[232:235], v[240:243]
    v_mfma_f32_16x16x32_bf16 v[244:247], v[56:59], v[232:235], v[244:247]
    v_mfma_f32_16x16x32_bf16 v[240:243], v[44:47], v[236:239], v[240:243]
    v_mfma_f32_16x16x32_bf16 v[244:247], v[60:63], v[236:239], v[244:247]
    v_mfma_f32_16x16x32_bf16 v[248:251], v[64:67], v[224:227], v[20:23]
    s_nop 5
    v_mul_f32 v240, s49, v240
    v_mul_f32 v241, s49, v241
    v_mfma_f32_16x16x32_bf16 v[252:255], v[80:83], v[224:227], v[20:23]
    v_exp_f32 v240, v240
    v_exp_f32 v241, v241
    v_mul_f32 v242, s49, v242
    v_mfma_f32_16x16x32_bf16 v[248:251], v[68:71], v[228:231], v[248:251]
    v_mul_f32 v243, s49, v243
    v_cvt_pk_bf16_f32 v176, v240, v241
    v_mfma_f32_16x16x32_bf16 v[252:255], v[84:87], v[228:231], v[252:255]
    v_exp_f32 v242, v242
    v_exp_f32 v243, v243
    v_mul_f32 v244, s49, v244
    v_mfma_f32_16x16x32_bf16 v[248:251], v[72:75], v[232:235], v[248:251]
    v_mul_f32 v245, s49, v245
    v_cvt_pk_bf16_f32 v177, v242, v243
    v_mfma_f32_16x16x32_bf16 v[252:255], v[88:91], v[232:235], v[252:255]
    v_exp_f32 v244, v244
    v_exp_f32 v245, v245
    v_mul_f32 v246, s49, v246
    v_mfma_f32_16x16x32_bf16 v[248:251], v[76:79], v[236:239], v[248:251]
    v_mul_f32 v247, s49, v247
    v_cvt_pk_bf16_f32 v178, v244, v245
    v_mfma_f32_16x16x32_bf16 v[252:255], v[92:95], v[236:239], v[252:255]
    v_exp_f32 v246, v246
    v_exp_f32 v247, v247
    s_nop 0
    v_cvt_pk_bf16_f32 v179, v246, v247
    v_mfma_f32_16x16x32_bf16 v[240:243], v[96:99], v[224:227], v[20:23]
    v_mul_f32 v248, s49, v248
    v_mul_f32 v249, s49, v249
    v_mfma_f32_16x16x32_bf16 v[244:247], v[112:115], v[224:227], v[20:23]
    v_exp_f32 v248, v248
    v_exp_f32 v249, v249
    v_mul_f32 v250, s49, v250
    v_mfma_f32_16x16x32_bf16 v[240:243], v[100:103], v[228:231], v[240:243]
    v_mul_f32 v251, s49, v251
    v_cvt_pk_bf16_f32 v180, v248, v249
    v_mfma_f32_16x16x32_bf16 v[244:247], v[116:119], v[228:231], v[244:247]
    v_exp_f32 v250, v250
    v_exp_f32 v251, v251
    v_mul_f32 v252, s49, v252
    v_mfma_f32_16x16x32_bf16 v[240:243], v[104:107], v[232:235], v[240:243]
    v_mul_f32 v253, s49, v253
    v_cvt_pk_bf16_f32 v181, v250, v251
    v_mfma_f32_16x16x32_bf16 v[244:247], v[120:123], v[232:235], v[244:247]
    v_exp_f32 v252, v252
    v_exp_f32 v253, v253
    v_mul_f32 v254, s49, v254
    v_mfma_f32_16x16x32_bf16 v[240:243], v[108:111], v[236:239], v[240:243]
    v_mul_f32 v255, s49, v255
    v_cvt_pk_bf16_f32 v182, v252, v253
    v_mfma_f32_16x16x32_bf16 v[244:247], v[124:127], v[236:239], v[244:247]
    v_exp_f32 v254, v254
    v_exp_f32 v255, v255
    s_nop 0
    v_cvt_pk_bf16_f32 v183, v254, v255
    v_mfma_f32_16x16x32_bf16 v[248:251], v[128:131], v[224:227], v[20:23]
    v_mul_f32 v240, s49, v240
    v_mul_f32 v241, s49, v241
    v_mfma_f32_16x16x32_bf16 v[252:255], v[144:147], v[224:227], v[20:23]
    v_exp_f32 v240, v240
    v_exp_f32 v241, v241
    v_mul_f32 v242, s49, v242
    v_mfma_f32_16x16x32_bf16 v[248:251], v[132:135], v[228:231], v[248:251]
    v_mul_f32 v243, s49, v243
    v_cvt_pk_bf16_f32 v184, v240, v241
    v_mfma_f32_16x16x32_bf16 v[252:255], v[148:151], v[228:231], v[252:255]
    v_exp_f32 v242, v242
    v_exp_f32 v243, v243
    v_mul_f32 v244, s49, v244
    v_mfma_f32_16x16x32_bf16 v[248:251], v[136:139], v[232:235], v[248:251]
    v_mul_f32 v245, s49, v245
    v_cvt_pk_bf16_f32 v185, v242, v243
    v_mfma_f32_16x16x32_bf16 v[252:255], v[152:155], v[232:235], v[252:255]
    v_exp_f32 v244, v244
    v_exp_f32 v245, v245
    v_mul_f32 v246, s49, v246
    v_mfma_f32_16x16x32_bf16 v[248:251], v[140:143], v[236:239], v[248:251]
    v_mul_f32 v247, s49, v247
    v_cvt_pk_bf16_f32 v186, v244, v245
    v_mfma_f32_16x16x32_bf16 v[252:255], v[156:159], v[236:239], v[252:255]
    v_exp_f32 v246, v246
    v_exp_f32 v247, v247
    s_nop 0
    v_cvt_pk_bf16_f32 v187, v246, v247
    s_add_u32 m0, s48, 49152
    s_add_u32 s47, s65, 12288
    buffer_load_dwordx4 v4, s[24:27], s47 offen offset:0 nt lds
    buffer_load_dwordx4 v5, s[24:27], s47 offen offset:1024 nt lds
    buffer_load_dwordx4 v6, s[24:27], s47 offen offset:2048 nt lds
    buffer_load_dwordx4 v9, s[24:27], s47 offen offset:3072 nt lds
    s_waitcnt vmcnt(4)
    ds_read_b128 v[224:227], v28 offset:32768
    ds_read_b128 v[228:231], v29 offset:32768
    ds_read_b128 v[232:235], v30 offset:32768
    ds_read_b128 v[236:239], v31 offset:32768
    v_mul_f32 v248, s49, v248
    v_mul_f32 v249, s49, v249
    v_exp_f32 v248, v248
    v_exp_f32 v249, v249
    v_mul_f32 v250, s49, v250
    v_mul_f32 v251, s49, v251
    v_cvt_pk_bf16_f32 v188, v248, v249
    v_exp_f32 v250, v250
    v_exp_f32 v251, v251
    v_mul_f32 v252, s49, v252
    v_mul_f32 v253, s49, v253
    v_cvt_pk_bf16_f32 v189, v250, v251
    v_exp_f32 v252, v252
    v_exp_f32 v253, v253
    v_mul_f32 v254, s49, v254
    v_mul_f32 v255, s49, v255
    v_cvt_pk_bf16_f32 v190, v252, v253
    v_exp_f32 v254, v254
    v_exp_f32 v255, v255
    s_nop 0
    v_cvt_pk_bf16_f32 v191, v254, v255
    v_mov_b32 v26, 0
    v_mov_b32 v27, 0
    s_waitcnt lgkmcnt(3)
    v_dot2c_f32_bf16 v26, v224, v224
    v_dot2c_f32_bf16 v27, v225, v225
    v_dot2c_f32_bf16 v26, v226, v226
    v_dot2c_f32_bf16 v27, v227, v227
    s_waitcnt lgkmcnt(2)
    v_dot2c_f32_bf16 v26, v228, v228
    v_dot2c_f32_bf16 v27, v229, v229
    v_dot2c_f32_bf16 v26, v230, v230
    v_dot2c_f32_bf16 v27, v231, v231
    s_waitcnt lgkmcnt(1)
    v_dot2c_f32_bf16 v26, v232, v232
    v_dot2c_f32_bf16 v27, v233, v233
    v_dot2c_f32_bf16 v26, v234, v234
    v_dot2c_f32_bf16 v27, v235, v235
    s_waitcnt lgkmcnt(0)
    v_dot2c_f32_bf16 v26, v236, v236
    v_dot2c_f32_bf16 v27, v237, v237
    v_dot2c_f32_bf16 v26, v238, v238
    v_dot2c_f32_bf16 v27, v239, v239
    s_nop 2
    v_add_f32 v26, v26, v27
    v_mov_b32 v27, v26
    s_nop 1
    v_permlane16_swap_b32 v26, v27
    v_add_f32 v26, v26, v27
    v_mov_b32 v27, v26
    s_nop 1
    v_permlane32_swap_b32 v26, v27
    v_add_f32 v26, v26, v27
    v_fma_f32 v20, v26, s50, v14
    v_fma_f32 v21, v26, s50, v14
    v_fma_f32 v22, v26, s50, v14
    v_fma_f32 v23, v26, s50, v14
    s_nop 1
    v_mfma_f32_16x16x32_bf16 v[240:243], v[32:35], v[224:227], v[20:23]
    v_mfma_f32_16x16x32_bf16 v[244:247], v[48:51], v[224:227], v[20:23]
    v_mfma_f32_16x16x32_bf16 v[240:243], v[36:39], v[228:231], v[240:243]
    v_mfma_f32_16x16x32_bf16 v[244:247], v[52:55], v[228:231], v[244:247]
    v_mfma_f32_16x16x32_bf16 v[240:243], v[40:43], v[232:235], v[240:243]
    v_mfma_f32_16x16x32_bf16 v[244:247], v[56:59], v[232:235], v[244:247]
    v_mfma_f32_16x16x32_bf16 v[240:243], v[44:47], v[236:239], v[240:243]
    v_mfma_f32_16x16x32_bf16 v[244:247], v[60:63], v[236:239], v[244:247]
    v_mfma_f32_16x16x32_bf16 v[248:251], v[64:67], v[224:227], v[20:23]
    s_nop 5
    v_mul_f32 v240, s49, v240
    v_mul_f32 v241, s49, v241
    v_mfma_f32_16x16x32_bf16 v[252:255], v[80:83], v[224:227], v[20:23]
    v_exp_f32 v240, v240
    v_exp_f32 v241, v241
    v_mul_f32 v242, s49, v242
    v_mfma_f32_16x16x32_bf16 v[248:251], v[68:71], v[228:231], v[248:251]
    v_mul_f32 v243, s49, v243
    v_cvt_pk_bf16_f32 v192, v240, v241
    v_mfma_f32_16x16x32_bf16 v[252:255], v[84:87], v[228:231], v[252:255]
    v_exp_f32 v242, v242
    v_exp_f32 v243, v243
    v_mul_f32 v244, s49, v244
    v_mfma_f32_16x16x32_bf16 v[248:251], v[72:75], v[232:235], v[248:251]
    v_mul_f32 v245, s49, v245
    v_cvt_pk_bf16_f32 v193, v242, v243
    v_mfma_f32_16x16x32_bf16 v[252:255], v[88:91], v[232:235], v[252:255]
    v_exp_f32 v244, v244
    v_exp_f32 v245, v245
    v_mul_f32 v246, s49, v246
    v_mfma_f32_16x16x32_bf16 v[248:251], v[76:79], v[236:239], v[248:251]
    v_mul_f32 v247, s49, v247
    v_cvt_pk_bf16_f32 v194, v244, v245
    v_mfma_f32_16x16x32_bf16 v[252:255], v[92:95], v[236:239], v[252:255]
    v_exp_f32 v246, v246
    v_exp_f32 v247, v247
    s_nop 0
    v_cvt_pk_bf16_f32 v195, v246, v247
    v_mfma_f32_16x16x32_bf16 v[240:243], v[96:99], v[224:227], v[20:23]
    v_mul_f32 v248, s49, v248
    v_mul_f32 v249, s49, v249
    v_mfma_f32_16x16x32_bf16 v[244:247], v[112:115], v[224:227], v[20:23]
    v_exp_f32 v248, v248
    v_exp_f32 v249, v249
    v_mul_f32 v250, s49, v250
    v_mfma_f32_16x16x32_bf16 v[240:243], v[100:103], v[228:231], v[240:243]
    v_mul_f32 v251, s49, v251
    v_cvt_pk_bf16_f32 v196, v248, v249
    v_mfma_f32_16x16x32_bf16 v[244:247], v[116:119], v[228:231], v[244:247]
    v_exp_f32 v250, v250
    v_exp_f32 v251, v251
    v_mul_f32 v252, s49, v252
    v_mfma_f32_16x16x32_bf16 v[240:243], v[104:107], v[232:235], v[240:243]
    v_mul_f32 v253, s49, v253
    v_cvt_pk_bf16_f32 v197, v250, v251
    v_mfma_f32_16x16x32_bf16 v[244:247], v[120:123], v[232:235], v[244:247]
    v_exp_f32 v252, v252
    v_exp_f32 v253, v253
    v_mul_f32 v254, s49, v254
    v_mfma_f32_16x16x32_bf16 v[240:243], v[108:111], v[236:239], v[240:243]
    v_mul_f32 v255, s49, v255
    v_cvt_pk_bf16_f32 v198, v252, v253
    v_mfma_f32_16x16x32_bf16 v[244:247], v[124:127], v[236:239], v[244:247]
    v_exp_f32 v254, v254
    v_exp_f32 v255, v255
    s_nop 0
    v_cvt_pk_bf16_f32 v199, v254, v255
    v_mfma_f32_16x16x32_bf16 v[248:251], v[128:131], v[224:227], v[20:23]
    v_mul_f32 v240, s49, v240
    v_mul_f32 v241, s49, v241
    v_mfma_f32_16x16x32_bf16 v[252:255], v[144:147], v[224:227], v[20:23]
    v_exp_f32 v240, v240
    v_exp_f32 v241, v241
    v_mul_f32 v242, s49, v242
    v_mfma_f32_16x16x32_bf16 v[248:251], v[132:135], v[228:231], v[248:251]
    v_mul_f32 v243, s49, v243
    v_cvt_pk_bf16_f32 v200, v240, v241
    v_mfma_f32_16x16x32_bf16 v[252:255], v[148:151], v[228:231], v[252:255]
    v_exp_f32 v242, v242
    v_exp_f32 v243, v243
    v_mul_f32 v244, s49, v244
    v_mfma_f32_16x16x32_bf16 v[248:251], v[136:139], v[232:235], v[248:251]
    v_mul_f32 v245, s49, v245
    v_cvt_pk_bf16_f32 v201, v242, v243
    v_mfma_f32_16x16x32_bf16 v[252:255], v[152:155], v[232:235], v[252:255]
    v_exp_f32 v244, v244
    v_exp_f32 v245, v245
    v_mul_f32 v246, s49, v246
    v_mfma_f32_16x16x32_bf16 v[248:251], v[140:143], v[236:239], v[248:251]
    v_mul_f32 v247, s49, v247
    v_cvt_pk_bf16_f32 v202, v244, v245
    v_mfma_f32_16x16x32_bf16 v[252:255], v[156:159], v[236:239], v[252:255]
    v_exp_f32 v246, v246
    v_exp_f32 v247, v247
    s_nop 0
    v_cvt_pk_bf16_f32 v203, v246, v247
    s_waitcnt vmcnt(0)
    ds_read_b128 v[224:227], v28 offset:49152
    ds_read_b128 v[228:231], v29 offset:49152
    ds_read_b128 v[232:235], v30 offset:49152
    ds_read_b128 v[236:239], v31 offset:49152
    v_mul_f32 v248, s49, v248
    v_mul_f32 v249, s49, v249
    v_exp_f32 v248, v248
    v_exp_f32 v249, v249
    v_mul_f32 v250, s49, v250
    v_mul_f32 v251, s49, v251
    v_cvt_pk_bf16_f32 v204, v248, v249
    v_exp_f32 v250, v250
    v_exp_f32 v251, v251
    v_mul_f32 v252, s49, v252
    v_mul_f32 v253, s49, v253
    v_cvt_pk_bf16_f32 v205, v250, v251
    v_exp_f32 v252, v252
    v_exp_f32 v253, v253
    v_mul_f32 v254, s49, v254
    v_mul_f32 v255, s49, v255
    v_cvt_pk_bf16_f32 v206, v252, v253
    v_exp_f32 v254, v254
    v_exp_f32 v255, v255
    s_nop 0
    v_cvt_pk_bf16_f32 v207, v254, v255
    v_mov_b32 v26, 0
    v_mov_b32 v27, 0
    s_waitcnt lgkmcnt(3)
    v_dot2c_f32_bf16 v26, v224, v224
    v_dot2c_f32_bf16 v27, v225, v225
    v_dot2c_f32_bf16 v26, v226, v226
    v_dot2c_f32_bf16 v27, v227, v227
    s_waitcnt lgkmcnt(2)
    v_dot2c_f32_bf16 v26, v228, v228
    v_dot2c_f32_bf16 v27, v229, v229
    v_dot2c_f32_bf16 v26, v230, v230
    v_dot2c_f32_bf16 v27, v231, v231
    s_waitcnt lgkmcnt(1)
    v_dot2c_f32_bf16 v26, v232, v232
    v_dot2c_f32_bf16 v27, v233, v233
    v_dot2c_f32_bf16 v26, v234, v234
    v_dot2c_f32_bf16 v27, v235, v235
    s_waitcnt lgkmcnt(0)
    v_dot2c_f32_bf16 v26, v236, v236
    v_dot2c_f32_bf16 v27, v237, v237
    v_dot2c_f32_bf16 v26, v238, v238
    v_dot2c_f32_bf16 v27, v239, v239
    s_nop 2
    v_add_f32 v26, v26, v27
    v_mov_b32 v27, v26
    s_nop 1
    v_permlane16_swap_b32 v26, v27
    v_add_f32 v26, v26, v27
    v_mov_b32 v27, v26
    s_nop 1
    v_permlane32_swap_b32 v26, v27
    v_add_f32 v26, v26, v27
    v_fma_f32 v20, v26, s50, v14
    v_fma_f32 v21, v26, s50, v14
    v_fma_f32 v22, v26, s50, v14
    v_fma_f32 v23, v26, s50, v14
    s_nop 1
    v_mfma_f32_16x16x32_bf16 v[240:243], v[32:35], v[224:227], v[20:23]
    v_mfma_f32_16x16x32_bf16 v[244:247], v[48:51], v[224:227], v[20:23]
    v_mfma_f32_16x16x32_bf16 v[240:243], v[36:39], v[228:231], v[240:243]
    v_mfma_f32_16x16x32_bf16 v[244:247], v[52:55], v[228:231], v[244:247]
    v_mfma_f32_16x16x32_bf16 v[240:243], v[40:43], v[232:235], v[240:243]
    v_mfma_f32_16x16x32_bf16 v[244:247], v[56:59], v[232:235], v[244:247]
    v_mfma_f32_16x16x32_bf16 v[240:243], v[44:47], v[236:239], v[240:243]
    v_mfma_f32_16x16x32_bf16 v[244:247], v[60:63], v[236:239], v[244:247]
    v_mfma_f32_16x16x32_bf16 v[248:251], v[64:67], v[224:227], v[20:23]
    s_nop 5
    v_mul_f32 v240, s49, v240
    v_mul_f32 v241, s49, v241
    v_mfma_f32_16x16x32_bf16 v[252:255], v[80:83], v[224:227], v[20:23]
    v_exp_f32 v240, v240
    v_exp_f32 v241, v241
    v_mul_f32 v242, s49, v242
    v_mfma_f32_16x16x32_bf16 v[248:251], v[68:71], v[228:231], v[248:251]
    v_mul_f32 v243, s49, v243
    v_cvt_pk_bf16_f32 v208, v240, v241
    v_mfma_f32_16x16x32_bf16 v[252:255], v[84:87], v[228:231], v[252:255]
    v_exp_f32 v242, v242
    v_exp_f32 v243, v243
    v_mul_f32 v244, s49, v244
    v_mfma_f32_16x16x32_bf16 v[248:251], v[72:75], v[232:235], v[248:251]
    v_mul_f32 v245, s49, v245
    v_cvt_pk_bf16_f32 v209, v242, v243
    v_mfma_f32_16x16x32_bf16 v[252:255], v[88:91], v[232:235], v[252:255]
    v_exp_f32 v244, v244
    v_exp_f32 v245, v245
    v_mul_f32 v246, s49, v246
    v_mfma_f32_16x16x32_bf16 v[248:251], v[76:79], v[236:239], v[248:251]
    v_mul_f32 v247, s49, v247
    v_cvt_pk_bf16_f32 v210, v244, v245
    v_mfma_f32_16x16x32_bf16 v[252:255], v[92:95], v[236:239], v[252:255]
    v_exp_f32 v246, v246
    v_exp_f32 v247, v247
    s_nop 0
    v_cvt_pk_bf16_f32 v211, v246, v247
    v_mfma_f32_16x16x32_bf16 v[240:243], v[96:99], v[224:227], v[20:23]
    v_mul_f32 v248, s49, v248
    v_mul_f32 v249, s49, v249
    v_mfma_f32_16x16x32_bf16 v[244:247], v[112:115], v[224:227], v[20:23]
    v_exp_f32 v248, v248
    v_exp_f32 v249, v249
    v_mul_f32 v250, s49, v250
    v_mfma_f32_16x16x32_bf16 v[240:243], v[100:103], v[228:231], v[240:243]
    v_mul_f32 v251, s49, v251
    v_cvt_pk_bf16_f32 v212, v248, v249
    v_mfma_f32_16x16x32_bf16 v[244:247], v[116:119], v[228:231], v[244:247]
    v_exp_f32 v250, v250
    v_exp_f32 v251, v251
    v_mul_f32 v252, s49, v252
    v_mfma_f32_16x16x32_bf16 v[240:243], v[104:107], v[232:235], v[240:243]
    v_mul_f32 v253, s49, v253
    v_cvt_pk_bf16_f32 v213, v250, v251
    v_mfma_f32_16x16x32_bf16 v[244:247], v[120:123], v[232:235], v[244:247]
    v_exp_f32 v252, v252
    v_exp_f32 v253, v253
    v_mul_f32 v254, s49, v254
    v_mfma_f32_16x16x32_bf16 v[240:243], v[108:111], v[236:239], v[240:243]
    v_mul_f32 v255, s49, v255
    v_cvt_pk_bf16_f32 v214, v252, v253
    v_mfma_f32_16x16x32_bf16 v[244:247], v[124:127], v[236:239], v[244:247]
    v_exp_f32 v254, v254
    v_exp_f32 v255, v255
    s_nop 0
    v_cvt_pk_bf16_f32 v215, v254, v255
    v_mfma_f32_16x16x32_bf16 v[248:251], v[128:131], v[224:227], v[20:23]
    v_mul_f32 v240, s49, v240
    v_mul_f32 v241, s49, v241
    v_mfma_f32_16x16x32_bf16 v[252:255], v[144:147], v[224:227], v[20:23]
    v_exp_f32 v240, v240
    v_exp_f32 v241, v241
    v_mul_f32 v242, s49, v242
    v_mfma_f32_16x16x32_bf16 v[248:251], v[132:135], v[228:231], v[248:251]
    v_mul_f32 v243, s49, v243
    v_cvt_pk_bf16_f32 v216, v240, v241
    v_mfma_f32_16x16x32_bf16 v[252:255], v[148:151], v[228:231], v[252:255]
    v_exp_f32 v242, v242
    v_exp_f32 v243, v243
    v_mul_f32 v244, s49, v244
    v_mfma_f32_16x16x32_bf16 v[248:251], v[136:139], v[232:235], v[248:251]
    v_mul_f32 v245, s49, v245
    v_cvt_pk_bf16_f32 v217, v242, v243
    v_mfma_f32_16x16x32_bf16 v[252:255], v[152:155], v[232:235], v[252:255]
    v_exp_f32 v244, v244
    v_exp_f32 v245, v245
    v_mul_f32 v246, s49, v246
    v_mfma_f32_16x16x32_bf16 v[248:251], v[140:143], v[236:239], v[248:251]
    v_mul_f32 v247, s49, v247
    v_cvt_pk_bf16_f32 v218, v244, v245
    v_mfma_f32_16x16x32_bf16 v[252:255], v[156:159], v[236:239], v[252:255]
    v_exp_f32 v246, v246
    v_exp_f32 v247, v247
    s_nop 0
    v_cvt_pk_bf16_f32 v219, v246, v247
    s_nop 0
    v_mul_f32 v248, s49, v248
    v_mul_f32 v249, s49, v249
    v_exp_f32 v248, v248
    v_exp_f32 v249, v249
    v_mul_f32 v250, s49, v250
    v_mul_f32 v251, s49, v251
    v_cvt_pk_bf16_f32 v220, v248, v249
    v_exp_f32 v250, v250
    v_exp_f32 v251, v251
    v_mul_f32 v252, s49, v252
    v_mul_f32 v253, s49, v253
    v_cvt_pk_bf16_f32 v221, v250, v251
    v_exp_f32 v252, v252
    v_exp_f32 v253, v253
    v_mul_f32 v254, s49, v254
    v_mul_f32 v255, s49, v255
    v_cvt_pk_bf16_f32 v222, v252, v253
    v_exp_f32 v254, v254
    v_exp_f32 v255, v255
    s_nop 0
    v_cvt_pk_bf16_f32 v223, v254, v255
    s_lshl_b32 s47, s53, 14
    v_lshlrev_b32 v9, 10, v2
    v_lshl_add_u32 v9, v3, 4, v9
    v_add_u32 v9, s47, v9
    v_lshlrev_b32 v7, 4, v0
    v_add_u32 v7, 123904, v7
    v_lshlrev_b32 v8, 4, v2
    v_add_u32 v8, 157184, v8
    s_barrier
    ds_read_b128 v[224:227], v8 offset:0
    ds_read_b128 v[228:231], v8 offset:64
    ds_read_b128 v[232:235], v8 offset:128
    ds_read_b128 v[236:239], v8 offset:192
    ds_read_b128 v[104:107], v7 offset:0
    ds_read_b128 v[108:111], v7 offset:1040
    ds_read_b128 v[112:115], v7 offset:2080
    ds_read_b128 v[116:119], v7 offset:3120
    ds_read_b128 v[120:123], v7 offset:4160
    ds_read_b128 v[124:127], v7 offset:5200
    ds_read_b128 v[128:131], v7 offset:6240
    ds_read_b128 v[132:135], v7 offset:7280
    ds_read_b128 v[136:139], v7 offset:8320
    ds_read_b128 v[140:143], v7 offset:9360
    ds_read_b128 v[144:147], v7 offset:10400
    ds_read_b128 v[148:151], v7 offset:11440
    s_waitcnt lgkmcnt(11)
    v_mfma_f32_16x16x32_bf16 v[32:35], v[160:163], v[104:107], 0
    v_mfma_f32_16x16x32_bf16 v[64:67], v[160:163], v[224:227], 0
    ds_read_b128 v[104:107], v7 offset:12480
    s_waitcnt lgkmcnt(11)
    v_mfma_f32_16x16x32_bf16 v[36:39], v[160:163], v[108:111], 0
    ds_read_b128 v[108:111], v7 offset:13520
    s_waitcnt lgkmcnt(11)
    v_mfma_f32_16x16x32_bf16 v[40:43], v[160:163], v[112:115], 0
    ds_read_b128 v[112:115], v7 offset:14560
    s_waitcnt lgkmcnt(11)
    v_mfma_f32_16x16x32_bf16 v[44:47], v[160:163], v[116:119], 0
    ds_read_b128 v[116:119], v7 offset:15600
    s_waitcnt lgkmcnt(11)
    v_mfma_f32_16x16x32_bf16 v[48:51], v[160:163], v[120:123], 0
    ds_read_b128 v[120:123], v7 offset:16640
    s_waitcnt lgkmcnt(11)
    v_mfma_f32_16x16x32_bf16 v[52:55], v[160:163], v[124:127], 0
    ds_read_b128 v[124:127], v7 offset:17680
    s_waitcnt lgkmcnt(11)
    v_mfma_f32_16x16x32_bf16 v[56:59], v[160:163], v[128:131], 0
    ds_read_b128 v[128:131], v7 offset:18720
    s_waitcnt lgkmcnt(11)
    v_mfma_f32_16x16x32_bf16 v[60:63], v[160:163], v[132:135], 0
    ds_read_b128 v[132:135], v7 offset:19760
    s_waitcnt lgkmcnt(11)
    v_mfma_f32_16x16x32_bf16 v[32:35], v[164:167], v[136:139], v[32:35]
    v_mfma_f32_16x16x32_bf16 v[64:67], v[164:167], v[228:231], v[64:67]
    ds_read_b128 v[136:139], v7 offset:20800
    s_waitcnt lgkmcnt(11)
    v_mfma_f32_16x16x32_bf16 v[36:39], v[164:167], v[140:143], v[36:39]
    ds_read_b128 v[140:143], v7 offset:21840
    s_waitcnt lgkmcnt(11)
    v_mfma_f32_16x16x32_bf16 v[40:43], v[164:167], v[144:147], v[40:43]
    ds_read_b128 v[144:147], v7 offset:22880
    s_waitcnt lgkmcnt(11)
    v_mfma_f32_16x16x32_bf16 v[44:47], v[164:167], v[148:151], v[44:47]
    ds_read_b128 v[148:151], v7 offset:23920
    s_waitcnt lgkmcnt(11)
    v_mfma_f32_16x16x32_bf16 v[48:51], v[164:167], v[104:107], v[48:51]
    ds_read_b128 v[104:107], v7 offset:24960
    s_waitcnt lgkmcnt(11)
    v_mfma_f32_16x16x32_bf16 v[52:55], v[164:167], v[108:111], v[52:55]
    ds_read_b128 v[108:111], v7 offset:26000
    s_waitcnt lgkmcnt(11)
    v_mfma_f32_16x16x32_bf16 v[56:59], v[164:167], v[112:115], v[56:59]
    ds_read_b128 v[112:115], v7 offset:27040
    s_waitcnt lgkmcnt(11)
    v_mfma_f32_16x16x32_bf16 v[60:63], v[164:167], v[116:119], v[60:63]
    ds_read_b128 v[116:119], v7 offset:28080
    s_waitcnt lgkmcnt(11)
    v_mfma_f32_16x16x32_bf16 v[32:35], v[168:171], v[120:123], v[32:35]
    v_mfma_f32_16x16x32_bf16 v[64:67], v[168:171], v[232:235], v[64:67]
    ds_read_b128 v[120:123], v7 offset:29120
    s_waitcnt lgkmcnt(11)
    v_mfma_f32_16x16x32_bf16 v[36:39], v[168:171], v[124:127], v[36:39]
    ds_read_b128 v[124:127], v7 offset:30160
    s_waitcnt lgkmcnt(11)
    v_mfma_f32_16x16x32_bf16 v[40:43], v[168:171], v[128:131], v[40:43]
    ds_read_b128 v[128:131], v7 offset:31200
    s_waitcnt lgkmcnt(11)
    v_mfma_f32_16x16x32_bf16 v[44:47], v[168:171], v[132:135], v[44:47]
    ds_read_b128 v[132:135], v7 offset:32240
    s_waitcnt lgkmcnt(11)
    v_mfma_f32_16x16x32_bf16 v[48:51], v[168:171], v[136:139], v[48:51]
    ds_read_b128 v[136:139], v7 offset:0
    s_waitcnt lgkmcnt(11)
    v_mfma_f32_16x16x32_bf16 v[52:55], v[168:171], v[140:143], v[52:55]
    ds_read_b128 v[140:143], v7 offset:1040
    s_waitcnt lgkmcnt(11)
    v_mfma_f32_16x16x32_bf16 v[56:59], v[168:171], v[144:147], v[56:59]
    ds_read_b128 v[144:147], v7 offset:2080
    s_waitcnt lgkmcnt(11)
    v_mfma_f32_16x16x32_bf16 v[60:63], v[168:171], v[148:151], v[60:63]
    ds_read_b128 v[148:151], v7 offset:3120
    s_waitcnt lgkmcnt(11)
    v_mfma_f32_16x16x32_bf16 v[32:35], v[172:175], v[104:107], v[32:35]
    v_mfma_f32_16x16x32_bf16 v[64:67], v[172:175], v[236:239], v[64:67]
    ds_read_b128 v[104:107], v7 offset:4160
    s_waitcnt lgkmcnt(11)
    v_mfma_f32_16x16x32_bf16 v[36:39], v[172:175], v[108:111], v[36:39]
    ds_read_b128 v[108:111], v7 offset:5200
    s_waitcnt lgkmcnt(11)
    v_mfma_f32_16x16x32_bf16 v[40:43], v[172:175], v[112:115], v[40:43]
    ds_read_b128 v[112:115], v7 offset:6240
    s_waitcnt lgkmcnt(11)
    v_mfma_f32_16x16x32_bf16 v[44:47], v[172:175], v[116:119], v[44:47]
    ds_read_b128 v[116:119], v7 offset:7280
    s_waitcnt lgkmcnt(11)
    v_mfma_f32_16x16x32_bf16 v[48:51], v[172:175], v[120:123], v[48:51]
    ds_read_b128 v[120:123], v7 offset:8320
    s_waitcnt lgkmcnt(11)
    v_mfma_f32_16x16x32_bf16 v[52:55], v[172:175], v[124:127], v[52:55]
    ds_read_b128 v[124:127], v7 offset:9360
    s_waitcnt lgkmcnt(11)
    v_mfma_f32_16x16x32_bf16 v[56:59], v[172:175], v[128:131], v[56:59]
    ds_read_b128 v[128:131], v7 offset:10400
    s_waitcnt lgkmcnt(11)
    v_mfma_f32_16x16x32_bf16 v[60:63], v[172:175], v[132:135], v[60:63]
    ds_read_b128 v[132:135], v7 offset:11440
    s_waitcnt lgkmcnt(11)
    v_mfma_f32_16x16x32_bf16 v[68:71], v[176:179], v[136:139], 0
    v_mfma_f32_16x16x32_bf16 v[100:103], v[176:179], v[224:227], 0
    ds_read_b128 v[136:139], v7 offset:12480
    s_waitcnt lgkmcnt(11)
    v_mfma_f32_16x16x32_bf16 v[72:75], v[176:179], v[140:143], 0
    v_add_f32 v64, s54, v64
    v_add_f32 v65, s54, v65
    v_add_f32 v66, s54, v66
    v_add_f32 v67, s54, v67
    ds_read_b128 v[140:143], v7 offset:13520
    s_waitcnt lgkmcnt(11)
    v_mfma_f32_16x16x32_bf16 v[76:79], v[176:179], v[144:147], 0
    v_rcp_f32 v64, v64
    v_rcp_f32 v65, v65
    ds_read_b128 v[144:147], v7 offset:14560
    s_waitcnt lgkmcnt(11)
    v_mfma_f32_16x16x32_bf16 v[80:83], v[176:179], v[148:151], 0
    v_rcp_f32 v66, v66
    v_rcp_f32 v67, v67
    ds_read_b128 v[148:151], v7 offset:15600
    s_waitcnt lgkmcnt(11)
    v_mfma_f32_16x16x32_bf16 v[84:87], v[176:179], v[104:107], 0
    v_mul_f32 v32, v32, v64
    v_mul_f32 v36, v36, v64
    v_cvt_pk_bf16_f32 v240, v32, v36
    ds_read_b128 v[104:107], v7 offset:16640
    s_waitcnt lgkmcnt(11)
    v_mfma_f32_16x16x32_bf16 v[88:91], v[176:179], v[108:111], 0
    v_mul_f32 v40, v40, v64
    v_mul_f32 v44, v44, v64
    v_cvt_pk_bf16_f32 v241, v40, v44
    ds_read_b128 v[108:111], v7 offset:17680
    s_waitcnt lgkmcnt(11)
    v_mfma_f32_16x16x32_bf16 v[92:95], v[176:179], v[112:115], 0
    v_mul_f32 v48, v48, v64
    v_mul_f32 v52, v52, v64
    v_cvt_pk_bf16_f32 v242, v48, v52
    ds_read_b128 v[112:115], v7 offset:18720
    s_waitcnt lgkmcnt(11)
    v_mfma_f32_16x16x32_bf16 v[96:99], v[176:179], v[116:119], 0
    v_mul_f32 v56, v56, v64
    v_mul_f32 v60, v60, v64
    v_cvt_pk_bf16_f32 v243, v56, v60
    buffer_store_dwordx4 v[240:243], v9, s[28:31], s56 offen offset:0 nt
    ds_read_b128 v[116:119], v7 offset:19760
    s_waitcnt lgkmcnt(11)
    v_mfma_f32_16x16x32_bf16 v[68:71], v[180:183], v[120:123], v[68:71]
    v_mfma_f32_16x16x32_bf16 v[100:103], v[180:183], v[228:231], v[100:103]
    v_mul_f32 v33, v33, v65
    v_mul_f32 v37, v37, v65
    v_cvt_pk_bf16_f32 v244, v33, v37
    ds_read_b128 v[120:123], v7 offset:20800
    s_waitcnt lgkmcnt(11)
    v_mfma_f32_16x16x32_bf16 v[72:75], v[180:183], v[124:127], v[72:75]
    v_mul_f32 v41, v41, v65
    v_mul_f32 v45, v45, v65
    v_cvt_pk_bf16_f32 v245, v41, v45
    ds_read_b128 v[124:127], v7 offset:21840
    s_waitcnt lgkmcnt(11)
    v_mfma_f32_16x16x32_bf16 v[76:79], v[180:183], v[128:131], v[76:79]
    v_mul_f32 v49, v49, v65
    v_mul_f32 v53, v53, v65
    v_cvt_pk_bf16_f32 v246, v49, v53
    ds_read_b128 v[128:131], v7 offset:22880
    s_waitcnt lgkmcnt(11)
    v_mfma_f32_16x16x32_bf16 v[80:83], v[180:183], v[132:135], v[80:83]
    v_mul_f32 v57, v57, v65
    v_mul_f32 v61, v61, v65
    v_cvt_pk_bf16_f32 v247, v57, v61
    buffer_store_dwordx4 v[244:247], v9, s[28:31], s56 offen offset:256 nt
    ds_read_b128 v[132:135], v7 offset:23920
    s_waitcnt lgkmcnt(11)
    v_mfma_f32_16x16x32_bf16 v[84:87], v[180:183], v[136:139], v[84:87]
    v_mul_f32 v34, v34, v66
    v_mul_f32 v38, v38, v66
    v_cvt_pk_bf16_f32 v248, v34, v38
    ds_read_b128 v[136:139], v7 offset:24960
    s_waitcnt lgkmcnt(11)
    v_mfma_f32_16x16x32_bf16 v[88:91], v[180:183], v[140:143], v[88:91]
    v_mul_f32 v42, v42, v66
    v_mul_f32 v46, v46, v66
    v_cvt_pk_bf16_f32 v249, v42, v46
    ds_read_b128 v[140:143], v7 offset:26000
    s_waitcnt lgkmcnt(11)
    v_mfma_f32_16x16x32_bf16 v[92:95], v[180:183], v[144:147], v[92:95]
    v_mul_f32 v50, v50, v66
    v_mul_f32 v54, v54, v66
    v_cvt_pk_bf16_f32 v250, v50, v54
    ds_read_b128 v[144:147], v7 offset:27040
    s_waitcnt lgkmcnt(11)
    v_mfma_f32_16x16x32_bf16 v[96:99], v[180:183], v[148:151], v[96:99]
    v_mul_f32 v58, v58, v66
    v_mul_f32 v62, v62, v66
    v_cvt_pk_bf16_f32 v251, v58, v62
    buffer_store_dwordx4 v[248:251], v9, s[28:31], s56 offen offset:512 nt
    ds_read_b128 v[148:151], v7 offset:28080
    s_waitcnt lgkmcnt(11)
    v_mfma_f32_16x16x32_bf16 v[68:71], v[184:187], v[104:107], v[68:71]
    v_mfma_f32_16x16x32_bf16 v[100:103], v[184:187], v[232:235], v[100:103]
    v_mul_f32 v35, v35, v67
    v_mul_f32 v39, v39, v67
    v_cvt_pk_bf16_f32 v252, v35, v39
    ds_read_b128 v[104:107], v7 offset:29120
    s_waitcnt lgkmcnt(11)
    v_mfma_f32_16x16x32_bf16 v[72:75], v[184:187], v[108:111], v[72:75]
    v_mul_f32 v43, v43, v67
    v_mul_f32 v47, v47, v67
    v_cvt_pk_bf16_f32 v253, v43, v47
    ds_read_b128 v[108:111], v7 offset:30160
    s_waitcnt lgkmcnt(11)
    v_mfma_f32_16x16x32_bf16 v[76:79], v[184:187], v[112:115], v[76:79]
    v_mul_f32 v51, v51, v67
    v_mul_f32 v55, v55, v67
    v_cvt_pk_bf16_f32 v254, v51, v55
    ds_read_b128 v[112:115], v7 offset:31200
    s_waitcnt lgkmcnt(11)
    v_mfma_f32_16x16x32_bf16 v[80:83], v[184:187], v[116:119], v[80:83]
    v_mul_f32 v59, v59, v67
    v_mul_f32 v63, v63, v67
    v_cvt_pk_bf16_f32 v255, v59, v63
    buffer_store_dwordx4 v[252:255], v9, s[28:31], s56 offen offset:768 nt
    ds_read_b128 v[116:119], v7 offset:32240
    s_waitcnt lgkmcnt(11)
    v_mfma_f32_16x16x32_bf16 v[84:87], v[184:187], v[120:123], v[84:87]
    ds_read_b128 v[120:123], v7 offset:0
    s_waitcnt lgkmcnt(11)
    v_mfma_f32_16x16x32_bf16 v[88:91], v[184:187], v[124:127], v[88:91]
    ds_read_b128 v[124:127], v7 offset:1040
    s_waitcnt lgkmcnt(11)
    v_mfma_f32_16x16x32_bf16 v[92:95], v[184:187], v[128:131], v[92:95]
    ds_read_b128 v[128:131], v7 offset:2080
    s_waitcnt lgkmcnt(11)
    v_mfma_f32_16x16x32_bf16 v[96:99], v[184:187], v[132:135], v[96:99]
    ds_read_b128 v[132:135], v7 offset:3120
    s_waitcnt lgkmcnt(11)
    v_mfma_f32_16x16x32_bf16 v[68:71], v[188:191], v[136:139], v[68:71]
    v_mfma_f32_16x16x32_bf16 v[100:103], v[188:191], v[236:239], v[100:103]
    ds_read_b128 v[136:139], v7 offset:4160
    s_waitcnt lgkmcnt(11)
    v_mfma_f32_16x16x32_bf16 v[72:75], v[188:191], v[140:143], v[72:75]
    ds_read_b128 v[140:143], v7 offset:5200
    s_waitcnt lgkmcnt(11)
    v_mfma_f32_16x16x32_bf16 v[76:79], v[188:191], v[144:147], v[76:79]
    ds_read_b128 v[144:147], v7 offset:6240
    s_waitcnt lgkmcnt(11)
    v_mfma_f32_16x16x32_bf16 v[80:83], v[188:191], v[148:151], v[80:83]
    ds_read_b128 v[148:151], v7 offset:7280
    s_waitcnt lgkmcnt(11)
    v_mfma_f32_16x16x32_bf16 v[84:87], v[188:191], v[104:107], v[84:87]
    ds_read_b128 v[104:107], v7 offset:8320
    s_waitcnt lgkmcnt(11)
    v_mfma_f32_16x16x32_bf16 v[88:91], v[188:191], v[108:111], v[88:91]
    ds_read_b128 v[108:111], v7 offset:9360
    s_waitcnt lgkmcnt(11)
    v_mfma_f32_16x16x32_bf16 v[92:95], v[188:191], v[112:115], v[92:95]
    ds_read_b128 v[112:115], v7 offset:10400
    s_waitcnt lgkmcnt(11)
    v_mfma_f32_16x16x32_bf16 v[96:99], v[188:191], v[116:119], v[96:99]
    ds_read_b128 v[116:119], v7 offset:11440
    s_waitcnt lgkmcnt(11)
    v_mfma_f32_16x16x32_bf16 v[32:35], v[192:195], v[120:123], 0
    v_mfma_f32_16x16x32_bf16 v[64:67], v[192:195], v[224:227], 0
    ds_read_b128 v[120:123], v7 offset:12480
    s_waitcnt lgkmcnt(11)
    v_mfma_f32_16x16x32_bf16 v[36:39], v[192:195], v[124:127], 0
    v_add_f32 v100, s54, v100
    v_add_f32 v101, s54, v101
    v_add_f32 v102, s54, v102
    v_add_f32 v103, s54, v103
    ds_read_b128 v[124:127], v7 offset:13520
    s_waitcnt lgkmcnt(11)
    v_mfma_f32_16x16x32_bf16 v[40:43], v[192:195], v[128:131], 0
    v_rcp_f32 v100, v100
    v_rcp_f32 v101, v101
    ds_read_b128 v[128:131], v7 offset:14560
    s_waitcnt lgkmcnt(11)
    v_mfma_f32_16x16x32_bf16 v[44:47], v[192:195], v[132:135], 0
    v_rcp_f32 v102, v102
    v_rcp_f32 v103, v103
    ds_read_b128 v[132:135], v7 offset:15600
    s_waitcnt lgkmcnt(11)
    v_mfma_f32_16x16x32_bf16 v[48:51], v[192:195], v[136:139], 0
    v_mul_f32 v68, v68, v100
    v_mul_f32 v72, v72, v100
    v_cvt_pk_bf16_f32 v240, v68, v72
    ds_read_b128 v[136:139], v7 offset:16640
    s_waitcnt lgkmcnt(11)
    v_mfma_f32_16x16x32_bf16 v[52:55], v[192:195], v[140:143], 0
    v_mul_f32 v76, v76, v100
    v_mul_f32 v80, v80, v100
    v_cvt_pk_bf16_f32 v241, v76, v80
    ds_read_b128 v[140:143], v7 offset:17680
    s_waitcnt lgkmcnt(11)
    v_mfma_f32_16x16x32_bf16 v[56:59], v[192:195], v[144:147], 0
    v_mul_f32 v84, v84, v100
    v_mul_f32 v88, v88, v100
    v_cvt_pk_bf16_f32 v242, v84, v88
    ds_read_b128 v[144:147], v7 offset:18720
    s_waitcnt lgkmcnt(11)
    v_mfma_f32_16x16x32_bf16 v[60:63], v[192:195], v[148:151], 0
    v_mul_f32 v92, v92, v100
    v_mul_f32 v96, v96, v100
    v_cvt_pk_bf16_f32 v243, v92, v96
    buffer_store_dwordx4 v[240:243], v9, s[28:31], s57 offen offset:0 nt
    ds_read_b128 v[148:151], v7 offset:19760
    s_waitcnt lgkmcnt(11)
    v_mfma_f32_16x16x32_bf16 v[32:35], v[196:199], v[104:107], v[32:35]
    v_mfma_f32_16x16x32_bf16 v[64:67], v[196:199], v[228:231], v[64:67]
    v_mul_f32 v69, v69, v101
    v_mul_f32 v73, v73, v101
    v_cvt_pk_bf16_f32 v244, v69, v73
    ds_read_b128 v[104:107], v7 offset:20800
    s_waitcnt lgkmcnt(11)
    v_mfma_f32_16x16x32_bf16 v[36:39], v[196:199], v[108:111], v[36:39]
    v_mul_f32 v77, v77, v101
    v_mul_f32 v81, v81, v101
    v_cvt_pk_bf16_f32 v245, v77, v81
    ds_read_b128 v[108:111], v7 offset:21840
    s_waitcnt lgkmcnt(11)
    v_mfma_f32_16x16x32_bf16 v[40:43], v[196:199], v[112:115], v[40:43]
    v_mul_f32 v85, v85, v101
    v_mul_f32 v89, v89, v101
    v_cvt_pk_bf16_f32 v246, v85, v89
    ds_read_b128 v[112:115], v7 offset:22880
    s_waitcnt lgkmcnt(11)
    v_mfma_f32_16x16x32_bf16 v[44:47], v[196:199], v[116:119], v[44:47]
    v_mul_f32 v93, v93, v101
    v_mul_f32 v97, v97, v101
    v_cvt_pk_bf16_f32 v247, v93, v97
    buffer_store_dwordx4 v[244:247], v9, s[28:31], s57 offen offset:256 nt
    ds_read_b128 v[116:119], v7 offset:23920
    s_waitcnt lgkmcnt(11)
    v_mfma_f32_16x16x32_bf16 v[48:51], v[196:199], v[120:123], v[48:51]
    v_mul_f32 v70, v70, v102
    v_mul_f32 v74, v74, v102
    v_cvt_pk_bf16_f32 v248, v70, v74
    ds_read_b128 v[120:123], v7 offset:24960
    s_waitcnt lgkmcnt(11)
    v_mfma_f32_16x16x32_bf16 v[52:55], v[196:199], v[124:127], v[52:55]
    v_mul_f32 v78, v78, v102
    v_mul_f32 v82, v82, v102
    v_cvt_pk_bf16_f32 v249, v78, v82
    ds_read_b128 v[124:127], v7 offset:26000
    s_waitcnt lgkmcnt(11)
    v_mfma_f32_16x16x32_bf16 v[56:59], v[196:199], v[128:131], v[56:59]
    v_mul_f32 v86, v86, v102
    v_mul_f32 v90, v90, v102
    v_cvt_pk_bf16_f32 v250, v86, v90
    ds_read_b128 v[128:131], v7 offset:27040
    s_waitcnt lgkmcnt(11)
    v_mfma_f32_16x16x32_bf16 v[60:63], v[196:199], v[132:135], v[60:63]
    v_mul_f32 v94, v94, v102
    v_mul_f32 v98, v98, v102
    v_cvt_pk_bf16_f32 v251, v94, v98
    buffer_store_dwordx4 v[248:251], v9, s[28:31], s57 offen offset:512 nt
    ds_read_b128 v[132:135], v7 offset:28080
    s_waitcnt lgkmcnt(11)
    v_mfma_f32_16x16x32_bf16 v[32:35], v[200:203], v[136:139], v[32:35]
    v_mfma_f32_16x16x32_bf16 v[64:67], v[200:203], v[232:235], v[64:67]
    v_mul_f32 v71, v71, v103
    v_mul_f32 v75, v75, v103
    v_cvt_pk_bf16_f32 v252, v71, v75
    ds_read_b128 v[136:139], v7 offset:29120
    s_waitcnt lgkmcnt(11)
    v_mfma_f32_16x16x32_bf16 v[36:39], v[200:203], v[140:143], v[36:39]
    v_mul_f32 v79, v79, v103
    v_mul_f32 v83, v83, v103
    v_cvt_pk_bf16_f32 v253, v79, v83
    ds_read_b128 v[140:143], v7 offset:30160
    s_waitcnt lgkmcnt(11)
    v_mfma_f32_16x16x32_bf16 v[40:43], v[200:203], v[144:147], v[40:43]
    v_mul_f32 v87, v87, v103
    v_mul_f32 v91, v91, v103
    v_cvt_pk_bf16_f32 v254, v87, v91
    ds_read_b128 v[144:147], v7 offset:31200
    s_waitcnt lgkmcnt(11)
    v_mfma_f32_16x16x32_bf16 v[44:47], v[200:203], v[148:151], v[44:47]
    v_mul_f32 v95, v95, v103
    v_mul_f32 v99, v99, v103
    v_cvt_pk_bf16_f32 v255, v95, v99
    buffer_store_dwordx4 v[252:255], v9, s[28:31], s57 offen offset:768 nt
    ds_read_b128 v[148:151], v7 offset:32240
    s_waitcnt lgkmcnt(11)
    v_mfma_f32_16x16x32_bf16 v[48:51], v[200:203], v[104:107], v[48:51]
    ds_read_b128 v[104:107], v7 offset:0
    s_waitcnt lgkmcnt(11)
    v_mfma_f32_16x16x32_bf16 v[52:55], v[200:203], v[108:111], v[52:55]
    ds_read_b128 v[108:111], v7 offset:1040
    s_waitcnt lgkmcnt(11)
    v_mfma_f32_16x16x32_bf16 v[56:59], v[200:203], v[112:115], v[56:59]
    ds_read_b128 v[112:115], v7 offset:2080
    s_waitcnt lgkmcnt(11)
    v_mfma_f32_16x16x32_bf16 v[60:63], v[200:203], v[116:119], v[60:63]
    ds_read_b128 v[116:119], v7 offset:3120
    s_waitcnt lgkmcnt(11)
    v_mfma_f32_16x16x32_bf16 v[32:35], v[204:207], v[120:123], v[32:35]
    v_mfma_f32_16x16x32_bf16 v[64:67], v[204:207], v[236:239], v[64:67]
    ds_read_b128 v[120:123], v7 offset:4160
    s_waitcnt lgkmcnt(11)
    v_mfma_f32_16x16x32_bf16 v[36:39], v[204:207], v[124:127], v[36:39]
    ds_read_b128 v[124:127], v7 offset:5200
    s_waitcnt lgkmcnt(11)
    v_mfma_f32_16x16x32_bf16 v[40:43], v[204:207], v[128:131], v[40:43]
    ds_read_b128 v[128:131], v7 offset:6240
    s_waitcnt lgkmcnt(11)
    v_mfma_f32_16x16x32_bf16 v[44:47], v[204:207], v[132:135], v[44:47]
    ds_read_b128 v[132:135], v7 offset:7280
    s_waitcnt lgkmcnt(11)
    v_mfma_f32_16x16x32_bf16 v[48:51], v[204:207], v[136:139], v[48:51]
    ds_read_b128 v[136:139], v7 offset:8320
    s_waitcnt lgkmcnt(11)
    v_mfma_f32_16x16x32_bf16 v[52:55], v[204:207], v[140:143], v[52:55]
    ds_read_b128 v[140:143], v7 offset:9360
    s_waitcnt lgkmcnt(11)
    v_mfma_f32_16x16x32_bf16 v[56:59], v[204:207], v[144:147], v[56:59]
    ds_read_b128 v[144:147], v7 offset:10400
    s_waitcnt lgkmcnt(11)
    v_mfma_f32_16x16x32_bf16 v[60:63], v[204:207], v[148:151], v[60:63]
    ds_read_b128 v[148:151], v7 offset:11440
    s_waitcnt lgkmcnt(11)
    v_mfma_f32_16x16x32_bf16 v[68:71], v[208:211], v[104:107], 0
    v_mfma_f32_16x16x32_bf16 v[100:103], v[208:211], v[224:227], 0
    ds_read_b128 v[104:107], v7 offset:12480
    s_waitcnt lgkmcnt(11)
    v_mfma_f32_16x16x32_bf16 v[72:75], v[208:211], v[108:111], 0
    v_add_f32 v64, s54, v64
    v_add_f32 v65, s54, v65
    v_add_f32 v66, s54, v66
    v_add_f32 v67, s54, v67
    ds_read_b128 v[108:111], v7 offset:13520
    s_waitcnt lgkmcnt(11)
    v_mfma_f32_16x16x32_bf16 v[76:79], v[208:211], v[112:115], 0
    v_rcp_f32 v64, v64
    v_rcp_f32 v65, v65
    ds_read_b128 v[112:115], v7 offset:14560
    s_waitcnt lgkmcnt(11)
    v_mfma_f32_16x16x32_bf16 v[80:83], v[208:211], v[116:119], 0
    v_rcp_f32 v66, v66
    v_rcp_f32 v67, v67
    ds_read_b128 v[116:119], v7 offset:15600
    s_waitcnt lgkmcnt(11)
    v_mfma_f32_16x16x32_bf16 v[84:87], v[208:211], v[120:123], 0
    v_mul_f32 v32, v32, v64
    v_mul_f32 v36, v36, v64
    v_cvt_pk_bf16_f32 v240, v32, v36
    ds_read_b128 v[120:123], v7 offset:16640
    s_waitcnt lgkmcnt(11)
    v_mfma_f32_16x16x32_bf16 v[88:91], v[208:211], v[124:127], 0
    v_mul_f32 v40, v40, v64
    v_mul_f32 v44, v44, v64
    v_cvt_pk_bf16_f32 v241, v40, v44
    ds_read_b128 v[124:127], v7 offset:17680
    s_waitcnt lgkmcnt(11)
    v_mfma_f32_16x16x32_bf16 v[92:95], v[208:211], v[128:131], 0
    v_mul_f32 v48, v48, v64
    v_mul_f32 v52, v52, v64
    v_cvt_pk_bf16_f32 v242, v48, v52
    ds_read_b128 v[128:131], v7 offset:18720
    s_waitcnt lgkmcnt(11)
    v_mfma_f32_16x16x32_bf16 v[96:99], v[208:211], v[132:135], 0
    v_mul_f32 v56, v56, v64
    v_mul_f32 v60, v60, v64
    v_cvt_pk_bf16_f32 v243, v56, v60
    buffer_store_dwordx4 v[240:243], v9, s[28:31], s58 offen offset:0 nt
    ds_read_b128 v[132:135], v7 offset:19760
    s_waitcnt lgkmcnt(11)
    v_mfma_f32_16x16x32_bf16 v[68:71], v[212:215], v[136:139], v[68:71]
    v_mfma_f32_16x16x32_bf16 v[100:103], v[212:215], v[228:231], v[100:103]
    v_mul_f32 v33, v33, v65
    v_mul_f32 v37, v37, v65
    v_cvt_pk_bf16_f32 v244, v33, v37
    ds_read_b128 v[136:139], v7 offset:20800
    s_waitcnt lgkmcnt(11)
    v_mfma_f32_16x16x32_bf16 v[72:75], v[212:215], v[140:143], v[72:75]
    v_mul_f32 v41, v41, v65
    v_mul_f32 v45, v45, v65
    v_cvt_pk_bf16_f32 v245, v41, v45
    ds_read_b128 v[140:143], v7 offset:21840
    s_waitcnt lgkmcnt(11)
    v_mfma_f32_16x16x32_bf16 v[76:79], v[212:215], v[144:147], v[76:79]
    v_mul_f32 v49, v49, v65
    v_mul_f32 v53, v53, v65
    v_cvt_pk_bf16_f32 v246, v49, v53
    ds_read_b128 v[144:147], v7 offset:22880
    s_waitcnt lgkmcnt(11)
    v_mfma_f32_16x16x32_bf16 v[80:83], v[212:215], v[148:151], v[80:83]
    v_mul_f32 v57, v57, v65
    v_mul_f32 v61, v61, v65
    v_cvt_pk_bf16_f32 v247, v57, v61
    buffer_store_dwordx4 v[244:247], v9, s[28:31], s58 offen offset:256 nt
    ds_read_b128 v[148:151], v7 offset:23920
    s_waitcnt lgkmcnt(11)
    v_mfma_f32_16x16x32_bf16 v[84:87], v[212:215], v[104:107], v[84:87]
    v_mul_f32 v34, v34, v66
    v_mul_f32 v38, v38, v66
    v_cvt_pk_bf16_f32 v248, v34, v38
    ds_read_b128 v[104:107], v7 offset:24960
    s_waitcnt lgkmcnt(11)
    v_mfma_f32_16x16x32_bf16 v[88:91], v[212:215], v[108:111], v[88:91]
    v_mul_f32 v42, v42, v66
    v_mul_f32 v46, v46, v66
    v_cvt_pk_bf16_f32 v249, v42, v46
    ds_read_b128 v[108:111], v7 offset:26000
    s_waitcnt lgkmcnt(11)
    v_mfma_f32_16x16x32_bf16 v[92:95], v[212:215], v[112:115], v[92:95]
    v_mul_f32 v50, v50, v66
    v_mul_f32 v54, v54, v66
    v_cvt_pk_bf16_f32 v250, v50, v54
    ds_read_b128 v[112:115], v7 offset:27040
    s_waitcnt lgkmcnt(11)
    v_mfma_f32_16x16x32_bf16 v[96:99], v[212:215], v[116:119], v[96:99]
    v_mul_f32 v58, v58, v66
    v_mul_f32 v62, v62, v66
    v_cvt_pk_bf16_f32 v251, v58, v62
    buffer_store_dwordx4 v[248:251], v9, s[28:31], s58 offen offset:512 nt
    ds_read_b128 v[116:119], v7 offset:28080
    s_waitcnt lgkmcnt(11)
    v_mfma_f32_16x16x32_bf16 v[68:71], v[216:219], v[120:123], v[68:71]
    v_mfma_f32_16x16x32_bf16 v[100:103], v[216:219], v[232:235], v[100:103]
    v_mul_f32 v35, v35, v67
    v_mul_f32 v39, v39, v67
    v_cvt_pk_bf16_f32 v252, v35, v39
    ds_read_b128 v[120:123], v7 offset:29120
    s_waitcnt lgkmcnt(11)
    v_mfma_f32_16x16x32_bf16 v[72:75], v[216:219], v[124:127], v[72:75]
    v_mul_f32 v43, v43, v67
    v_mul_f32 v47, v47, v67
    v_cvt_pk_bf16_f32 v253, v43, v47
    ds_read_b128 v[124:127], v7 offset:30160
    s_waitcnt lgkmcnt(11)
    v_mfma_f32_16x16x32_bf16 v[76:79], v[216:219], v[128:131], v[76:79]
    v_mul_f32 v51, v51, v67
    v_mul_f32 v55, v55, v67
    v_cvt_pk_bf16_f32 v254, v51, v55
    ds_read_b128 v[128:131], v7 offset:31200
    s_waitcnt lgkmcnt(11)
    v_mfma_f32_16x16x32_bf16 v[80:83], v[216:219], v[132:135], v[80:83]
    v_mul_f32 v59, v59, v67
    v_mul_f32 v63, v63, v67
    v_cvt_pk_bf16_f32 v255, v59, v63
    buffer_store_dwordx4 v[252:255], v9, s[28:31], s58 offen offset:768 nt
    ds_read_b128 v[132:135], v7 offset:32240
    s_waitcnt lgkmcnt(11)
    v_mfma_f32_16x16x32_bf16 v[84:87], v[216:219], v[136:139], v[84:87]
    s_waitcnt lgkmcnt(10)
    v_mfma_f32_16x16x32_bf16 v[88:91], v[216:219], v[140:143], v[88:91]
    s_waitcnt lgkmcnt(9)
    v_mfma_f32_16x16x32_bf16 v[92:95], v[216:219], v[144:147], v[92:95]
    s_waitcnt lgkmcnt(8)
    v_mfma_f32_16x16x32_bf16 v[96:99], v[216:219], v[148:151], v[96:99]
    s_waitcnt lgkmcnt(7)
    v_mfma_f32_16x16x32_bf16 v[68:71], v[220:223], v[104:107], v[68:71]
    v_mfma_f32_16x16x32_bf16 v[100:103], v[220:223], v[236:239], v[100:103]
    s_waitcnt lgkmcnt(6)
    v_mfma_f32_16x16x32_bf16 v[72:75], v[220:223], v[108:111], v[72:75]
    s_waitcnt lgkmcnt(5)
    v_mfma_f32_16x16x32_bf16 v[76:79], v[220:223], v[112:115], v[76:79]
    s_waitcnt lgkmcnt(4)
    v_mfma_f32_16x16x32_bf16 v[80:83], v[220:223], v[116:119], v[80:83]
    s_waitcnt lgkmcnt(3)
    v_mfma_f32_16x16x32_bf16 v[84:87], v[220:223], v[120:123], v[84:87]
    s_waitcnt lgkmcnt(2)
    v_mfma_f32_16x16x32_bf16 v[88:91], v[220:223], v[124:127], v[88:91]
    s_waitcnt lgkmcnt(1)
    v_mfma_f32_16x16x32_bf16 v[92:95], v[220:223], v[128:131], v[92:95]
    s_waitcnt lgkmcnt(0)
    v_mfma_f32_16x16x32_bf16 v[96:99], v[220:223], v[132:135], v[96:99]
    v_add_f32 v100, s54, v100
    v_add_f32 v101, s54, v101
    v_add_f32 v102, s54, v102
    v_add_f32 v103, s54, v103
    v_rcp_f32 v100, v100
    v_rcp_f32 v101, v101
    v_rcp_f32 v102, v102
    v_rcp_f32 v103, v103
    v_mul_f32 v68, v68, v100
    v_mul_f32 v72, v72, v100
    v_cvt_pk_bf16_f32 v240, v68, v72
    v_mul_f32 v76, v76, v100
    v_mul_f32 v80, v80, v100
    v_cvt_pk_bf16_f32 v241, v76, v80
    v_mul_f32 v84, v84, v100
    v_mul_f32 v88, v88, v100
    v_cvt_pk_bf16_f32 v242, v84, v88
    v_mul_f32 v92, v92, v100
    v_mul_f32 v96, v96, v100
    v_cvt_pk_bf16_f32 v243, v92, v96
    buffer_store_dwordx4 v[240:243], v9, s[28:31], s59 offen offset:0 nt
    v_mul_f32 v69, v69, v101
    v_mul_f32 v73, v73, v101
    v_cvt_pk_bf16_f32 v244, v69, v73
    v_mul_f32 v77, v77, v101
    v_mul_f32 v81, v81, v101
    v_cvt_pk_bf16_f32 v245, v77, v81
    v_mul_f32 v85, v85, v101
    v_mul_f32 v89, v89, v101
    v_cvt_pk_bf16_f32 v246, v85, v89
    v_mul_f32 v93, v93, v101
    v_mul_f32 v97, v97, v101
    v_cvt_pk_bf16_f32 v247, v93, v97
    buffer_store_dwordx4 v[244:247], v9, s[28:31], s59 offen offset:256 nt
    v_mul_f32 v70, v70, v102
    v_mul_f32 v74, v74, v102
    v_cvt_pk_bf16_f32 v248, v70, v74
    v_mul_f32 v78, v78, v102
    v_mul_f32 v82, v82, v102
    v_cvt_pk_bf16_f32 v249, v78, v82
    v_mul_f32 v86, v86, v102
    v_mul_f32 v90, v90, v102
    v_cvt_pk_bf16_f32 v250, v86, v90
    v_mul_f32 v94, v94, v102
    v_mul_f32 v98, v98, v102
    v_cvt_pk_bf16_f32 v251, v94, v98
    buffer_store_dwordx4 v[248:251], v9, s[28:31], s59 offen offset:512 nt
    v_mul_f32 v71, v71, v103
    v_mul_f32 v75, v75, v103
    v_cvt_pk_bf16_f32 v252, v71, v75
    v_mul_f32 v79, v79, v103
    v_mul_f32 v83, v83, v103
    v_cvt_pk_bf16_f32 v253, v79, v83
    v_mul_f32 v87, v87, v103
    v_mul_f32 v91, v91, v103
    v_cvt_pk_bf16_f32 v254, v87, v91
    v_mul_f32 v95, v95, v103
    v_mul_f32 v99, v99, v103
    v_cvt_pk_bf16_f32 v255, v95, v99
    buffer_store_dwordx4 v[252:255], v9, s[28:31], s59 offen offset:768 nt
L_end:
    s_endpgm
L_kv:
    s_getpc_b64 s[86:87]
    s_sub_u32 s86, s86, . - standalone__linear_kernel_performer__prompt_kernel
    s_subb_u32 s87, s87, 0
    s_lshl_b32 s48, s44, 13
    v_lshl_add_u32 v6, v0, 7, s48
    global_load_dword v255, v6, s[86:87]
    s_and_b32 s93, s44, 1
    s_lshr_b32 s94, s44, 1
    s_and_b32 s95, s46, 1
    v_lshrrev_b32 v2, 4, v0
    v_and_b32 v3, 15, v0
    v_and_b32 v1, 31, v0
    s_mul_i32 s64, s45, 139264
    s_waitcnt lgkmcnt(0)
    s_mov_b32 s40, s14
    s_mov_b32 s41, s15
    s_mov_b32 s42, 256
    s_mov_b32 s43, 0x00020000
    s_add_u32 s36, s60, s64
    s_addc_u32 s37, s61, 0
    s_mov_b32 s38, 139264
    s_mov_b32 s39, 0x00020000
    s_lshr_b32 s57, s46, 1
    s_lshl_b32 s56, s46, 2
    s_add_u32 s56, s56, s44
    s_xor_b32 s47, s56, 0
    s_mul_i32 s4, s47, 4352
    s_xor_b32 s47, s56, 4
    s_mul_i32 s5, s47, 4352
    s_xor_b32 s47, s56, 8
    s_mul_i32 s6, s47, 4352
    s_xor_b32 s47, s56, 12
    s_mul_i32 s7, s47, 4352
    s_xor_b32 s47, s56, 16
    s_mul_i32 s8, s47, 4352
    s_xor_b32 s47, s56, 20
    s_mul_i32 s9, s47, 4352
    s_xor_b32 s47, s56, 24
    s_mul_i32 s10, s47, 4352
    s_xor_b32 s47, s56, 28
    s_mul_i32 s11, s47, 4352
    s_getreg_b32 s58, hwreg(HW_REG_XCC_ID, 0, 4)
    s_and_b32 s58, s58, 7
    s_lshl_b32 s58, s58, 2
    s_mov_b32 s12, 0x00003f80
    s_mov_b32 s13, 0x3f800000
    s_mov_b32 s50, s49
    s_mov_b32 s51, s49
    s_lshl_b32 s65, s45, 3
    v_mov_b32 v232, -1
    v_mov_b32 v233, -1
    v_mov_b32 v234, -1
    v_mov_b32 v235, -1
    v_mov_b32 v9, 0
    v_mov_b32 v236, 0
    v_mov_b32 v237, 0
    v_mov_b32 v238, 0
    v_mov_b32 v239, 0
    v_mov_b32 v248, 0x3f803f80
    v_mov_b32 v249, 0x3f803f80
    v_mov_b32 v250, 0x3f803f80
    v_mov_b32 v251, 0x3f803f80
    v_lshlrev_b32 v6, 4, v0
    v_lshlrev_b32 v7, 2, v1
    v_lshlrev_b32 v8, 2, v0
    v_xor_b32 v4, v2, v3
    v_lshlrev_b32 v4, 4, v4
    v_lshl_add_u32 v4, v3, 8, v4
    s_lshl_b32 s47, s94, 13
    v_add_u32 v5, s47, v4
    v_xor_b32 v10, 0, v5
    v_xor_b32 v11, 64, v5
    v_xor_b32 v12, 128, v5
    v_xor_b32 v13, 192, v5
    s_lshl_b32 s48, s93, 13
    s_add_u32 s48, s48, 123904
    v_add_u32 v5, s48, v4
    v_xor_b32 v96, 0, v5
    v_xor_b32 v97, 64, v5
    v_xor_b32 v98, 128, v5
    v_xor_b32 v99, 192, v5
    v_lshrrev_b32 v4, 2, v3
    v_lshl_add_u32 v4, v2, 2, v4
    v_and_b32 v5, 7, v4
    s_lshl_b32 s48, s94, 2
    s_or_b32 s48, s48, s57
    v_xor_b32 v5, s48, v5
    v_lshlrev_b32 v5, 5, v5
    v_lshl_add_u32 v5, v4, 8, v5
    v_and_b32 v4, 3, v3
    v_lshl_add_u32 v5, v4, 3, v5
    s_add_u32 s48, s47, 65536
    v_add_u32 v5, s48, v5
    v_xor_b32 v14, 0, v5
    v_xor_b32 v15, 32, v5
    v_xor_b32 v16, 64, v5
    v_xor_b32 v17, 96, v5
    v_xor_b32 v18, 0x2000, v14
    v_xor_b32 v19, 0x2000, v15
    v_xor_b32 v20, 0x2000, v16
    v_xor_b32 v21, 0x2000, v17
    s_lshl_b32 s47, s94, 7
    s_add_u32 s47, s47, 122880
    v_lshl_add_u32 v22, v2, 4, s47
    s_lshl_b32 s47, s44, 11
    s_add_u32 s48, s47, 114688
    v_lshl_add_u32 v23, v0, 4, s48
    v_xor_b32 v24, 0x1000, v23
    s_lshl_b32 s47, s44, 7
    s_add_u32 s48, s47, 123392
    v_lshl_add_u32 v30, v1, 2, s48
    v_xor_b32 v25, 256, v30
    v_mov_b32 v31, 157440
    v_and_b32 v4, 7, v3
    v_mul_u32_u24 v4, 1040, v4
    v_lshl_add_u32 v4, v2, 8, v4
    v_lshrrev_b32 v5, 3, v3
    v_lshl_add_u32 v4, v5, 4, v4
    s_lshl_b32 s47, s94, 7
    s_add_u32 s47, s47, 123904
    v_add_u32 v4, s47, v4
    s_xor_b32 s47, s46, 0
    s_add_u32 s48, s93, 0
    s_mul_i32 s48, s48, 8320
    s_lshr_b32 s47, s47, 1
    s_lshl_b32 s47, s47, 5
    s_add_u32 s48, s48, s47
    v_add_u32 v224, s48, v4
    s_xor_b32 s47, s46, 1
    s_add_u32 s48, s93, 2
    s_mul_i32 s48, s48, 8320
    s_lshr_b32 s47, s47, 1
    s_lshl_b32 s47, s47, 5
    s_add_u32 s48, s48, s47
    v_add_u32 v225, s48, v4
    s_xor_b32 s47, s46, 2
    s_add_u32 s48, s93, 0
    s_mul_i32 s48, s48, 8320
    s_lshr_b32 s47, s47, 1
    s_lshl_b32 s47, s47, 5
    s_add_u32 s48, s48, s47
    v_add_u32 v226, s48, v4
    s_xor_b32 s47, s46, 3
    s_add_u32 s48, s93, 2
    s_mul_i32 s48, s48, 8320
    s_lshr_b32 s47, s47, 1
    s_lshl_b32 s47, s47, 5
    s_add_u32 s48, s48, s47
    v_add_u32 v227, s48, v4
    s_xor_b32 s47, s46, 4
    s_add_u32 s48, s93, 0
    s_mul_i32 s48, s48, 8320
    s_lshr_b32 s47, s47, 1
    s_lshl_b32 s47, s47, 5
    s_add_u32 s48, s48, s47
    v_add_u32 v228, s48, v4
    s_xor_b32 s47, s46, 5
    s_add_u32 s48, s93, 2
    s_mul_i32 s48, s48, 8320
    s_lshr_b32 s47, s47, 1
    s_lshl_b32 s47, s47, 5
    s_add_u32 s48, s48, s47
    v_add_u32 v229, s48, v4
    s_xor_b32 s47, s46, 6
    s_add_u32 s48, s93, 0
    s_mul_i32 s48, s48, 8320
    s_lshr_b32 s47, s47, 1
    s_lshl_b32 s47, s47, 5
    s_add_u32 s48, s48, s47
    v_add_u32 v230, s48, v4
    s_xor_b32 s47, s46, 7
    s_add_u32 s48, s93, 2
    s_mul_i32 s48, s48, 8320
    s_lshr_b32 s47, s47, 1
    s_lshl_b32 s47, s47, 5
    s_add_u32 s48, s48, s47
    v_add_u32 v231, s48, v4
    v_bfe_u32 v4, v1, 2, 2
    v_lshlrev_b32 v4, 4, v4
    v_lshrrev_b32 v5, 4, v1
    v_lshl_add_u32 v4, v5, 3, v4
    v_and_b32 v5, 3, v1
    v_lshl_add_u32 v4, v5, 1, v4
    s_lshl_b32 s47, s93, 6
    s_add_u32 s47, s47, 157184
    v_add_u32 v28, s47, v4
    v_xor_b32 v29, 128, v28
    s_barrier
    ds_read_b128 v[32:35], v96 offset:0
    ds_read_b128 v[36:39], v97 offset:0
    ds_read_b128 v[40:43], v98 offset:0
    ds_read_b128 v[44:47], v99 offset:0
    ds_read_b128 v[48:51], v96 offset:4096
    ds_read_b128 v[52:55], v97 offset:4096
    ds_read_b128 v[56:59], v98 offset:4096
    ds_read_b128 v[60:63], v99 offset:4096
    ds_read_b128 v[216:219], v22 offset:0
    ds_read_b128 v[220:223], v22 offset:64
    ds_read_b128 v[64:67], v10 offset:0
    ds_read_b128 v[80:83], v10 offset:4096
    ds_read_b128 v[68:71], v11 offset:0
    ds_read_b128 v[84:87], v11 offset:4096
    ds_read_b128 v[72:75], v12 offset:0
    ds_read_b128 v[88:91], v12 offset:4096
    ds_read_b128 v[76:79], v13 offset:0
    s_waitcnt lgkmcnt(4)
    v_mfma_f32_16x16x32_bf16 v[128:131], v[64:67], v[32:35], v[216:219]
    v_mfma_f32_16x16x32_bf16 v[136:139], v[64:67], v[48:51], v[216:219]
    ds_read_b128 v[92:95], v13 offset:4096
    v_mfma_f32_16x16x32_bf16 v[132:135], v[80:83], v[32:35], v[220:223]
    v_mfma_f32_16x16x32_bf16 v[140:143], v[80:83], v[48:51], v[220:223]
    v_mfma_f32_16x16x32_bf16 v[128:131], v[68:71], v[36:39], v[128:131]
    v_mfma_f32_16x16x32_bf16 v[136:139], v[68:71], v[52:55], v[136:139]
    s_waitcnt lgkmcnt(2)
    v_mfma_f32_16x16x32_bf16 v[132:135], v[84:87], v[36:39], v[132:135]
    v_mfma_f32_16x16x32_bf16 v[140:143], v[84:87], v[52:55], v[140:143]
    v_mfma_f32_16x16x32_bf16 v[128:131], v[72:75], v[40:43], v[128:131]
    v_mfma_f32_16x16x32_bf16 v[136:139], v[72:75], v[56:59], v[136:139]
    v_mfma_f32_16x16x32_bf16 v[132:135], v[88:91], v[40:43], v[132:135]
    v_mfma_f32_16x16x32_bf16 v[140:143], v[88:91], v[56:59], v[140:143]
    s_waitcnt lgkmcnt(0)
    v_mfma_f32_16x16x32_bf16 v[128:131], v[76:79], v[44:47], v[128:131]
    v_mfma_f32_16x16x32_bf16 v[136:139], v[76:79], v[60:63], v[136:139]
    v_mfma_f32_16x16x32_bf16 v[132:135], v[92:95], v[44:47], v[132:135]
    v_mfma_f32_16x16x32_bf16 v[140:143], v[92:95], v[60:63], v[140:143]
    s_waitcnt lgkmcnt(0)
    s_barrier
    ds_read_b128 v[216:219], v22 offset:256
    ds_read_b128 v[220:223], v22 offset:320
    ds_read_b128 v[64:67], v10 offset:16384
    ds_read_b128 v[80:83], v10 offset:20480
    ds_read_b128 v[68:71], v11 offset:16384
    ds_read_b128 v[84:87], v11 offset:20480
    ds_read_b128 v[72:75], v12 offset:16384
    ds_read_b128 v[88:91], v12 offset:20480
    ds_read_b128 v[76:79], v13 offset:16384
    s_waitcnt lgkmcnt(4)
    v_mfma_f32_16x16x32_bf16 v[144:147], v[64:67], v[32:35], v[216:219]
    v_mfma_f32_16x16x32_bf16 v[152:155], v[64:67], v[48:51], v[216:219]
    ds_read_b128 v[92:95], v13 offset:20480
    v_mfma_f32_16x16x32_bf16 v[148:151], v[80:83], v[32:35], v[220:223]
    v_mul_f32 v128, s49, v128
    v_mul_f32 v129, s49, v129
    v_exp_f32 v128, v128
    v_mfma_f32_16x16x32_bf16 v[156:159], v[80:83], v[48:51], v[220:223]
    v_exp_f32 v129, v129
    v_mul_f32 v130, s49, v130
    v_mul_f32 v131, s49, v131
    v_cvt_pk_bf16_f32 v160, v128, v129
    v_exp_f32 v130, v130
    v_mfma_f32_16x16x32_bf16 v[144:147], v[68:71], v[36:39], v[144:147]
    v_exp_f32 v131, v131
    v_add_f32 v236, v236, v128
    v_add_f32 v237, v237, v129
    v_mul_f32 v132, s49, v132
    v_mul_f32 v133, s49, v133
    v_cvt_pk_bf16_f32 v161, v130, v131
    v_exp_f32 v132, v132
    v_mfma_f32_16x16x32_bf16 v[152:155], v[68:71], v[52:55], v[152:155]
    v_exp_f32 v133, v133
    v_add_f32 v236, v236, v130
    v_add_f32 v237, v237, v131
    v_mul_f32 v134, s49, v134
    v_mul_f32 v135, s49, v135
    v_cvt_pk_bf16_f32 v162, v132, v133
    s_waitcnt lgkmcnt(2)
    v_mfma_f32_16x16x32_bf16 v[148:151], v[84:87], v[36:39], v[148:151]
    v_exp_f32 v134, v134
    v_exp_f32 v135, v135
    v_add_f32 v236, v236, v132
    v_add_f32 v237, v237, v133
    v_mul_f32 v136, s49, v136
    v_mul_f32 v137, s49, v137
    v_mfma_f32_16x16x32_bf16 v[156:159], v[84:87], v[52:55], v[156:159]
    v_cvt_pk_bf16_f32 v163, v134, v135
    v_exp_f32 v136, v136
    v_exp_f32 v137, v137
    ds_write_b128 v23, v[160:163] offset:25600
    v_mfma_f32_16x16x32_bf16 v[144:147], v[72:75], v[40:43], v[144:147]
    v_add_f32 v236, v236, v134
    v_add_f32 v237, v237, v135
    v_mul_f32 v138, s49, v138
    v_mul_f32 v139, s49, v139
    v_cvt_pk_bf16_f32 v164, v136, v137
    v_exp_f32 v138, v138
    v_mfma_f32_16x16x32_bf16 v[152:155], v[72:75], v[56:59], v[152:155]
    v_exp_f32 v139, v139
    v_add_f32 v238, v238, v136
    v_add_f32 v239, v239, v137
    v_mul_f32 v140, s49, v140
    v_mul_f32 v141, s49, v141
    v_cvt_pk_bf16_f32 v165, v138, v139
    v_mfma_f32_16x16x32_bf16 v[148:151], v[88:91], v[40:43], v[148:151]
    v_exp_f32 v140, v140
    v_exp_f32 v141, v141
    v_add_f32 v238, v238, v138
    v_add_f32 v239, v239, v139
    v_mul_f32 v142, s49, v142
    v_mul_f32 v143, s49, v143
    v_mfma_f32_16x16x32_bf16 v[156:159], v[88:91], v[56:59], v[156:159]
    v_cvt_pk_bf16_f32 v166, v140, v141
    v_exp_f32 v142, v142
    v_exp_f32 v143, v143
    v_add_f32 v238, v238, v140
    v_add_f32 v239, v239, v141
    v_cvt_pk_bf16_f32 v167, v142, v143
    s_waitcnt lgkmcnt(1)
    v_mfma_f32_16x16x32_bf16 v[144:147], v[76:79], v[44:47], v[144:147]
    ds_write_b128 v23, v[164:167] offset:26624
    v_add_f32 v238, v238, v142
    v_add_f32 v239, v239, v143
    v_mfma_f32_16x16x32_bf16 v[152:155], v[76:79], v[60:63], v[152:155]
    v_mfma_f32_16x16x32_bf16 v[148:151], v[92:95], v[44:47], v[148:151]
    v_mfma_f32_16x16x32_bf16 v[156:159], v[92:95], v[60:63], v[156:159]
    s_waitcnt lgkmcnt(0)
    s_barrier
    ds_read_b64_tr_b16 v[96:97], v14 offset:0
    ds_read_b64_tr_b16 v[98:99], v14 offset:4096
    ds_read_b64_tr_b16 v[100:101], v15 offset:0
    ds_read_b64_tr_b16 v[102:103], v15 offset:4096
    ds_read_b64_tr_b16 v[104:105], v16 offset:0
    ds_read_b64_tr_b16 v[106:107], v16 offset:4096
    ds_read_b64_tr_b16 v[108:109], v17 offset:0
    ds_read_b64_tr_b16 v[110:111], v17 offset:4096
    ds_read_b128 v[216:219], v22 offset:0
    ds_read_b128 v[220:223], v22 offset:64
    ds_read_b128 v[64:67], v10 offset:32768
    ds_read_b128 v[80:83], v10 offset:36864
    ds_read_b128 v[68:71], v11 offset:32768
    s_waitcnt lgkmcnt(7)
    v_mfma_f32_16x16x32_bf16 v[184:187], v[160:163], v[96:99], 0
    v_mfma_f32_16x16x32_bf16 v[188:191], v[164:167], v[96:99], 0
    ds_read_b128 v[84:87], v11 offset:36864
    v_mfma_f32_16x16x32_bf16 v[192:195], v[160:163], v[100:103], 0
    v_mfma_f32_16x16x32_bf16 v[196:199], v[164:167], v[100:103], 0
    ds_read_b128 v[72:75], v12 offset:32768
    v_mfma_f32_16x16x32_bf16 v[200:203], v[160:163], v[104:107], 0
    v_mfma_f32_16x16x32_bf16 v[204:207], v[164:167], v[104:107], 0
    ds_read_b128 v[88:91], v12 offset:36864
    s_waitcnt lgkmcnt(4)
    v_mfma_f32_16x16x32_bf16 v[208:211], v[160:163], v[108:111], 0
    v_mul_f32 v144, s49, v144
    v_mul_f32 v145, s49, v145
    v_exp_f32 v144, v144
    v_mfma_f32_16x16x32_bf16 v[212:215], v[164:167], v[108:111], 0
    ds_read_b128 v[76:79], v13 offset:32768
    v_exp_f32 v145, v145
    v_mfma_f32_16x16x32_bf16 v[128:131], v[64:67], v[32:35], v[216:219]
    v_mul_f32 v146, s49, v146
    v_mul_f32 v147, s49, v147
    v_cvt_pk_bf16_f32 v168, v144, v145
    v_mfma_f32_16x16x32_bf16 v[136:139], v[64:67], v[48:51], v[216:219]
    ds_read_b128 v[92:95], v13 offset:36864
    v_exp_f32 v146, v146
    v_mfma_f32_16x16x32_bf16 v[132:135], v[80:83], v[32:35], v[220:223]
    v_exp_f32 v147, v147
    v_add_f32 v236, v236, v144
    v_add_f32 v237, v237, v145
    v_mul_f32 v148, s49, v148
    v_mfma_f32_16x16x32_bf16 v[140:143], v[80:83], v[48:51], v[220:223]
    ds_read_b128 v[176:179], v24 offset:25600
    ds_read_b128 v[180:183], v24 offset:26624
    ds_read_b64_tr_b16 v[112:113], v18 offset:0
    ds_read_b64_tr_b16 v[114:115], v18 offset:4096
    s_waitcnt lgkmcnt(7)
    v_mfma_f32_16x16x32_bf16 v[128:131], v[68:71], v[36:39], v[128:131]
    v_mfma_f32_16x16x32_bf16 v[136:139], v[68:71], v[52:55], v[136:139]
    ds_read_b64_tr_b16 v[116:117], v19 offset:0
    ds_read_b64_tr_b16 v[118:119], v19 offset:4096
    v_mul_f32 v149, s49, v149
    v_cvt_pk_bf16_f32 v169, v146, v147
    v_mfma_f32_16x16x32_bf16 v[132:135], v[84:87], v[36:39], v[132:135]
    v_exp_f32 v148, v148
    v_exp_f32 v149, v149
    v_add_f32 v236, v236, v146
    v_mfma_f32_16x16x32_bf16 v[140:143], v[84:87], v[52:55], v[140:143]
    ds_read_b64_tr_b16 v[120:121], v20 offset:0
    ds_read_b64_tr_b16 v[122:123], v20 offset:4096
    v_add_f32 v237, v237, v147
    v_mul_f32 v150, s49, v150
    v_mfma_f32_16x16x32_bf16 v[128:131], v[72:75], v[40:43], v[128:131]
    v_mul_f32 v151, s49, v151
    v_cvt_pk_bf16_f32 v170, v148, v149
    v_exp_f32 v150, v150
    v_mfma_f32_16x16x32_bf16 v[136:139], v[72:75], v[56:59], v[136:139]
    ds_read_b64_tr_b16 v[124:125], v21 offset:0
    ds_read_b64_tr_b16 v[126:127], v21 offset:4096
    v_exp_f32 v151, v151
    s_waitcnt lgkmcnt(10)
    v_mfma_f32_16x16x32_bf16 v[132:135], v[88:91], v[40:43], v[132:135]
    v_add_f32 v236, v236, v148
    v_add_f32 v237, v237, v149
    v_mul_f32 v152, s49, v152
    v_mul_f32 v153, s49, v153
    v_cvt_pk_bf16_f32 v171, v150, v151
    v_mfma_f32_16x16x32_bf16 v[140:143], v[88:91], v[56:59], v[140:143]
    v_exp_f32 v152, v152
    v_exp_f32 v153, v153
    v_mfma_f32_16x16x32_bf16 v[128:131], v[76:79], v[44:47], v[128:131]
    ds_write_b128 v23, v[168:171] offset:0
    v_mfma_f32_16x16x32_bf16 v[136:139], v[76:79], v[60:63], v[136:139]
    v_add_f32 v236, v236, v150
    v_add_f32 v237, v237, v151
    v_mul_f32 v154, s49, v154
    v_mul_f32 v155, s49, v155
    v_cvt_pk_bf16_f32 v172, v152, v153
    v_mfma_f32_16x16x32_bf16 v[132:135], v[92:95], v[44:47], v[132:135]
    v_exp_f32 v154, v154
    v_exp_f32 v155, v155
    v_mfma_f32_16x16x32_bf16 v[140:143], v[92:95], v[60:63], v[140:143]
    v_add_f32 v238, v238, v152
    v_add_f32 v239, v239, v153
    v_mul_f32 v156, s49, v156
    v_mul_f32 v157, s49, v157
    v_cvt_pk_bf16_f32 v173, v154, v155
    s_waitcnt lgkmcnt(3)
    v_mfma_f32_16x16x32_bf16 v[184:187], v[176:179], v[112:115], v[184:187]
    v_exp_f32 v156, v156
    v_exp_f32 v157, v157
    v_add_f32 v238, v238, v154
    v_mfma_f32_16x16x32_bf16 v[188:191], v[180:183], v[112:115], v[188:191]
    v_add_f32 v239, v239, v155
    v_mul_f32 v158, s49, v158
    v_mul_f32 v159, s49, v159
    v_cvt_pk_bf16_f32 v174, v156, v157
    v_mfma_f32_16x16x32_bf16 v[192:195], v[176:179], v[116:119], v[192:195]
    v_exp_f32 v158, v158
    v_exp_f32 v159, v159
    v_add_f32 v238, v238, v156
    v_mfma_f32_16x16x32_bf16 v[196:199], v[180:183], v[116:119], v[196:199]
    v_add_f32 v239, v239, v157
    v_cvt_pk_bf16_f32 v175, v158, v159
    ds_write_b128 v23, v[172:175] offset:1024
    v_mfma_f32_16x16x32_bf16 v[200:203], v[176:179], v[120:123], v[200:203]
    v_add_f32 v238, v238, v158
    v_add_f32 v239, v239, v159
    v_mfma_f32_16x16x32_bf16 v[204:207], v[180:183], v[120:123], v[204:207]
    s_waitcnt lgkmcnt(2)
    v_mfma_f32_16x16x32_bf16 v[208:211], v[176:179], v[124:127], v[208:211]
    v_mfma_f32_16x16x32_bf16 v[212:215], v[180:183], v[124:127], v[212:215]
    s_waitcnt lgkmcnt(0)
    s_barrier
    ds_read_b64_tr_b16 v[96:97], v14 offset:16384
    ds_read_b64_tr_b16 v[98:99], v14 offset:20480
    ds_read_b64_tr_b16 v[100:101], v15 offset:16384
    ds_read_b64_tr_b16 v[102:103], v15 offset:20480
    ds_read_b64_tr_b16 v[104:105], v16 offset:16384
    ds_read_b64_tr_b16 v[106:107], v16 offset:20480
    ds_read_b64_tr_b16 v[108:109], v17 offset:16384
    ds_read_b64_tr_b16 v[110:111], v17 offset:20480
    ds_read_b128 v[216:219], v22 offset:256
    ds_read_b128 v[220:223], v22 offset:320
    ds_read_b128 v[64:67], v10 offset:49152
    ds_read_b128 v[80:83], v10 offset:53248
    ds_read_b128 v[68:71], v11 offset:49152
    s_waitcnt lgkmcnt(7)
    v_mfma_f32_16x16x32_bf16 v[184:187], v[168:171], v[96:99], v[184:187]
    v_mfma_f32_16x16x32_bf16 v[188:191], v[172:175], v[96:99], v[188:191]
    ds_read_b128 v[84:87], v11 offset:53248
    v_mfma_f32_16x16x32_bf16 v[192:195], v[168:171], v[100:103], v[192:195]
    v_mfma_f32_16x16x32_bf16 v[196:199], v[172:175], v[100:103], v[196:199]
    ds_read_b128 v[72:75], v12 offset:49152
    v_mfma_f32_16x16x32_bf16 v[200:203], v[168:171], v[104:107], v[200:203]
    v_mfma_f32_16x16x32_bf16 v[204:207], v[172:175], v[104:107], v[204:207]
    ds_read_b128 v[88:91], v12 offset:53248
    s_waitcnt lgkmcnt(4)
    v_mfma_f32_16x16x32_bf16 v[208:211], v[168:171], v[108:111], v[208:211]
    v_mul_f32 v128, s49, v128
    v_mul_f32 v129, s49, v129
    v_exp_f32 v128, v128
    v_mfma_f32_16x16x32_bf16 v[212:215], v[172:175], v[108:111], v[212:215]
    ds_read_b128 v[76:79], v13 offset:49152
    v_exp_f32 v129, v129
    v_mfma_f32_16x16x32_bf16 v[144:147], v[64:67], v[32:35], v[216:219]
    v_mul_f32 v130, s49, v130
    v_mul_f32 v131, s49, v131
    v_cvt_pk_bf16_f32 v160, v128, v129
    v_mfma_f32_16x16x32_bf16 v[152:155], v[64:67], v[48:51], v[216:219]
    ds_read_b128 v[92:95], v13 offset:53248
    v_exp_f32 v130, v130
    v_mfma_f32_16x16x32_bf16 v[148:151], v[80:83], v[32:35], v[220:223]
    v_exp_f32 v131, v131
    v_add_f32 v236, v236, v128
    v_add_f32 v237, v237, v129
    v_mul_f32 v132, s49, v132
    v_mfma_f32_16x16x32_bf16 v[156:159], v[80:83], v[48:51], v[220:223]
    ds_read_b128 v[176:179], v24 offset:0
    ds_read_b128 v[180:183], v24 offset:1024
    ds_read_b64_tr_b16 v[112:113], v18 offset:16384
    ds_read_b64_tr_b16 v[114:115], v18 offset:20480
    s_waitcnt lgkmcnt(7)
    v_mfma_f32_16x16x32_bf16 v[144:147], v[68:71], v[36:39], v[144:147]
    v_mfma_f32_16x16x32_bf16 v[152:155], v[68:71], v[52:55], v[152:155]
    ds_read_b64_tr_b16 v[116:117], v19 offset:16384
    ds_read_b64_tr_b16 v[118:119], v19 offset:20480
    v_mul_f32 v133, s49, v133
    v_cvt_pk_bf16_f32 v161, v130, v131
    v_mfma_f32_16x16x32_bf16 v[148:151], v[84:87], v[36:39], v[148:151]
    v_exp_f32 v132, v132
    v_exp_f32 v133, v133
    v_add_f32 v236, v236, v130
    v_mfma_f32_16x16x32_bf16 v[156:159], v[84:87], v[52:55], v[156:159]
    ds_read_b64_tr_b16 v[120:121], v20 offset:16384
    ds_read_b64_tr_b16 v[122:123], v20 offset:20480
    v_add_f32 v237, v237, v131
    v_mul_f32 v134, s49, v134
    v_mfma_f32_16x16x32_bf16 v[144:147], v[72:75], v[40:43], v[144:147]
    v_mul_f32 v135, s49, v135
    v_cvt_pk_bf16_f32 v162, v132, v133
    v_exp_f32 v134, v134
    v_mfma_f32_16x16x32_bf16 v[152:155], v[72:75], v[56:59], v[152:155]
    ds_read_b64_tr_b16 v[124:125], v21 offset:16384
    ds_read_b64_tr_b16 v[126:127], v21 offset:20480
    v_exp_f32 v135, v135
    s_waitcnt lgkmcnt(10)
    v_mfma_f32_16x16x32_bf16 v[148:151], v[88:91], v[40:43], v[148:151]
    v_add_f32 v236, v236, v132
    v_add_f32 v237, v237, v133
    v_mul_f32 v136, s49, v136
    v_mul_f32 v137, s49, v137
    v_cvt_pk_bf16_f32 v163, v134, v135
    v_mfma_f32_16x16x32_bf16 v[156:159], v[88:91], v[56:59], v[156:159]
    v_exp_f32 v136, v136
    v_exp_f32 v137, v137
    v_mfma_f32_16x16x32_bf16 v[144:147], v[76:79], v[44:47], v[144:147]
    ds_write_b128 v23, v[160:163] offset:25600
    v_mfma_f32_16x16x32_bf16 v[152:155], v[76:79], v[60:63], v[152:155]
    v_add_f32 v236, v236, v134
    v_add_f32 v237, v237, v135
    v_mul_f32 v138, s49, v138
    v_mul_f32 v139, s49, v139
    v_cvt_pk_bf16_f32 v164, v136, v137
    v_mfma_f32_16x16x32_bf16 v[148:151], v[92:95], v[44:47], v[148:151]
    v_exp_f32 v138, v138
    v_exp_f32 v139, v139
    v_mfma_f32_16x16x32_bf16 v[156:159], v[92:95], v[60:63], v[156:159]
    v_add_f32 v238, v238, v136
    v_add_f32 v239, v239, v137
    v_mul_f32 v140, s49, v140
    v_mul_f32 v141, s49, v141
    v_cvt_pk_bf16_f32 v165, v138, v139
    s_waitcnt lgkmcnt(3)
    v_mfma_f32_16x16x32_bf16 v[184:187], v[176:179], v[112:115], v[184:187]
    v_exp_f32 v140, v140
    v_exp_f32 v141, v141
    v_add_f32 v238, v238, v138
    v_mfma_f32_16x16x32_bf16 v[188:191], v[180:183], v[112:115], v[188:191]
    v_add_f32 v239, v239, v139
    v_mul_f32 v142, s49, v142
    v_mul_f32 v143, s49, v143
    v_cvt_pk_bf16_f32 v166, v140, v141
    v_mfma_f32_16x16x32_bf16 v[192:195], v[176:179], v[116:119], v[192:195]
    v_exp_f32 v142, v142
    v_exp_f32 v143, v143
    v_add_f32 v238, v238, v140
    v_mfma_f32_16x16x32_bf16 v[196:199], v[180:183], v[116:119], v[196:199]
    v_add_f32 v239, v239, v141
    v_cvt_pk_bf16_f32 v167, v142, v143
    ds_write_b128 v23, v[164:167] offset:26624
    v_mfma_f32_16x16x32_bf16 v[200:203], v[176:179], v[120:123], v[200:203]
    v_add_f32 v238, v238, v142
    v_add_f32 v239, v239, v143
    v_mfma_f32_16x16x32_bf16 v[204:207], v[180:183], v[120:123], v[204:207]
    s_waitcnt lgkmcnt(2)
    v_mfma_f32_16x16x32_bf16 v[208:211], v[176:179], v[124:127], v[208:211]
    v_mfma_f32_16x16x32_bf16 v[212:215], v[180:183], v[124:127], v[212:215]
    s_waitcnt lgkmcnt(0)
    s_barrier
    ds_read_b64_tr_b16 v[96:97], v14 offset:58368
    ds_read_b64_tr_b16 v[98:99], v14 offset:62464
    ds_read_b64_tr_b16 v[100:101], v15 offset:58368
    ds_read_b64_tr_b16 v[102:103], v15 offset:62464
    ds_read_b64_tr_b16 v[104:105], v16 offset:58368
    ds_read_b64_tr_b16 v[106:107], v16 offset:62464
    ds_read_b64_tr_b16 v[108:109], v17 offset:58368
    ds_read_b64_tr_b16 v[110:111], v17 offset:62464
    ds_read_b128 v[216:219], v22 offset:0
    ds_read_b128 v[220:223], v22 offset:64
    ds_read_b128 v[64:67], v10 offset:0
    ds_read_b128 v[80:83], v10 offset:4096
    ds_read_b128 v[68:71], v11 offset:0
    s_waitcnt lgkmcnt(7)
    v_mfma_f32_16x16x32_bf16 v[184:187], v[160:163], v[96:99], v[184:187]
    v_mfma_f32_16x16x32_bf16 v[188:191], v[164:167], v[96:99], v[188:191]
    ds_read_b128 v[84:87], v11 offset:4096
    v_mfma_f32_16x16x32_bf16 v[192:195], v[160:163], v[100:103], v[192:195]
    v_mfma_f32_16x16x32_bf16 v[196:199], v[164:167], v[100:103], v[196:199]
    ds_read_b128 v[72:75], v12 offset:0
    v_mfma_f32_16x16x32_bf16 v[200:203], v[160:163], v[104:107], v[200:203]
    v_mfma_f32_16x16x32_bf16 v[204:207], v[164:167], v[104:107], v[204:207]
    ds_read_b128 v[88:91], v12 offset:4096
    s_waitcnt lgkmcnt(4)
    v_mfma_f32_16x16x32_bf16 v[208:211], v[160:163], v[108:111], v[208:211]
    v_mul_f32 v144, s49, v144
    v_mul_f32 v145, s49, v145
    v_exp_f32 v144, v144
    v_mfma_f32_16x16x32_bf16 v[212:215], v[164:167], v[108:111], v[212:215]
    ds_read_b128 v[76:79], v13 offset:0
    v_exp_f32 v145, v145
    v_mfma_f32_16x16x32_bf16 v[128:131], v[64:67], v[32:35], v[216:219]
    v_mul_f32 v146, s49, v146
    v_mul_f32 v147, s49, v147
    v_cvt_pk_bf16_f32 v168, v144, v145
    v_mfma_f32_16x16x32_bf16 v[136:139], v[64:67], v[48:51], v[216:219]
    ds_read_b128 v[92:95], v13 offset:4096
    v_exp_f32 v146, v146
    v_mfma_f32_16x16x32_bf16 v[132:135], v[80:83], v[32:35], v[220:223]
    v_exp_f32 v147, v147
    v_add_f32 v236, v236, v144
    v_add_f32 v237, v237, v145
    v_mul_f32 v148, s49, v148
    v_mfma_f32_16x16x32_bf16 v[140:143], v[80:83], v[48:51], v[220:223]
    ds_read_b128 v[176:179], v24 offset:25600
    ds_read_b128 v[180:183], v24 offset:26624
    ds_read_b64_tr_b16 v[112:113], v18 offset:58368
    ds_read_b64_tr_b16 v[114:115], v18 offset:62464
    s_waitcnt lgkmcnt(7)
    v_mfma_f32_16x16x32_bf16 v[128:131], v[68:71], v[36:39], v[128:131]
    v_mfma_f32_16x16x32_bf16 v[136:139], v[68:71], v[52:55], v[136:139]
    ds_read_b64_tr_b16 v[116:117], v19 offset:58368
    ds_read_b64_tr_b16 v[118:119], v19 offset:62464
    v_mul_f32 v149, s49, v149
    v_cvt_pk_bf16_f32 v169, v146, v147
    v_mfma_f32_16x16x32_bf16 v[132:135], v[84:87], v[36:39], v[132:135]
    v_exp_f32 v148, v148
    v_exp_f32 v149, v149
    v_add_f32 v236, v236, v146
    v_mfma_f32_16x16x32_bf16 v[140:143], v[84:87], v[52:55], v[140:143]
    ds_read_b64_tr_b16 v[120:121], v20 offset:58368
    ds_read_b64_tr_b16 v[122:123], v20 offset:62464
    v_add_f32 v237, v237, v147
    v_mul_f32 v150, s49, v150
    v_mfma_f32_16x16x32_bf16 v[128:131], v[72:75], v[40:43], v[128:131]
    v_mul_f32 v151, s49, v151
    v_cvt_pk_bf16_f32 v170, v148, v149
    v_exp_f32 v150, v150
    v_mfma_f32_16x16x32_bf16 v[136:139], v[72:75], v[56:59], v[136:139]
    ds_read_b64_tr_b16 v[124:125], v21 offset:58368
    ds_read_b64_tr_b16 v[126:127], v21 offset:62464
    v_exp_f32 v151, v151
    s_waitcnt lgkmcnt(10)
    v_mfma_f32_16x16x32_bf16 v[132:135], v[88:91], v[40:43], v[132:135]
    v_add_f32 v236, v236, v148
    v_add_f32 v237, v237, v149
    v_mul_f32 v152, s49, v152
    v_mul_f32 v153, s49, v153
    v_cvt_pk_bf16_f32 v171, v150, v151
    v_mfma_f32_16x16x32_bf16 v[140:143], v[88:91], v[56:59], v[140:143]
    v_exp_f32 v152, v152
    v_exp_f32 v153, v153
    v_mfma_f32_16x16x32_bf16 v[128:131], v[76:79], v[44:47], v[128:131]
    ds_write_b128 v23, v[168:171] offset:0
    v_mfma_f32_16x16x32_bf16 v[136:139], v[76:79], v[60:63], v[136:139]
    v_add_f32 v236, v236, v150
    v_add_f32 v237, v237, v151
    v_mul_f32 v154, s49, v154
    v_mul_f32 v155, s49, v155
    v_cvt_pk_bf16_f32 v172, v152, v153
    v_mfma_f32_16x16x32_bf16 v[132:135], v[92:95], v[44:47], v[132:135]
    v_exp_f32 v154, v154
    v_exp_f32 v155, v155
    v_mfma_f32_16x16x32_bf16 v[140:143], v[92:95], v[60:63], v[140:143]
    v_add_f32 v238, v238, v152
    v_add_f32 v239, v239, v153
    v_mul_f32 v156, s49, v156
    v_mul_f32 v157, s49, v157
    v_cvt_pk_bf16_f32 v173, v154, v155
    s_waitcnt lgkmcnt(3)
    v_mfma_f32_16x16x32_bf16 v[184:187], v[176:179], v[112:115], v[184:187]
    v_exp_f32 v156, v156
    v_exp_f32 v157, v157
    v_add_f32 v238, v238, v154
    v_mfma_f32_16x16x32_bf16 v[188:191], v[180:183], v[112:115], v[188:191]
    v_add_f32 v239, v239, v155
    v_mul_f32 v158, s49, v158
    v_mul_f32 v159, s49, v159
    v_cvt_pk_bf16_f32 v174, v156, v157
    v_mfma_f32_16x16x32_bf16 v[192:195], v[176:179], v[116:119], v[192:195]
    v_exp_f32 v158, v158
    v_exp_f32 v159, v159
    v_add_f32 v238, v238, v156
    v_mfma_f32_16x16x32_bf16 v[196:199], v[180:183], v[116:119], v[196:199]
    v_add_f32 v239, v239, v157
    v_cvt_pk_bf16_f32 v175, v158, v159
    ds_write_b128 v23, v[172:175] offset:1024
    v_mfma_f32_16x16x32_bf16 v[200:203], v[176:179], v[120:123], v[200:203]
    v_add_f32 v238, v238, v158
    v_add_f32 v239, v239, v159
    v_mfma_f32_16x16x32_bf16 v[204:207], v[180:183], v[120:123], v[204:207]
    s_waitcnt lgkmcnt(2)
    v_mfma_f32_16x16x32_bf16 v[208:211], v[176:179], v[124:127], v[208:211]
    v_mfma_f32_16x16x32_bf16 v[212:215], v[180:183], v[124:127], v[212:215]
    s_waitcnt lgkmcnt(0)
    s_barrier
    ds_read_b64_tr_b16 v[96:97], v14 offset:32768
    ds_read_b64_tr_b16 v[98:99], v14 offset:36864
    ds_read_b64_tr_b16 v[100:101], v15 offset:32768
    ds_read_b64_tr_b16 v[102:103], v15 offset:36864
    ds_read_b64_tr_b16 v[104:105], v16 offset:32768
    ds_read_b64_tr_b16 v[106:107], v16 offset:36864
    ds_read_b64_tr_b16 v[108:109], v17 offset:32768
    ds_read_b64_tr_b16 v[110:111], v17 offset:36864
    ds_read_b128 v[216:219], v22 offset:256
    ds_read_b128 v[220:223], v22 offset:320
    ds_read_b128 v[64:67], v10 offset:16384
    ds_read_b128 v[80:83], v10 offset:20480
    ds_read_b128 v[68:71], v11 offset:16384
    s_waitcnt lgkmcnt(7)
    v_mfma_f32_16x16x32_bf16 v[184:187], v[168:171], v[96:99], v[184:187]
    v_mfma_f32_16x16x32_bf16 v[188:191], v[172:175], v[96:99], v[188:191]
    ds_read_b128 v[84:87], v11 offset:20480
    v_mfma_f32_16x16x32_bf16 v[192:195], v[168:171], v[100:103], v[192:195]
    v_mfma_f32_16x16x32_bf16 v[196:199], v[172:175], v[100:103], v[196:199]
    ds_read_b128 v[72:75], v12 offset:16384
    v_mfma_f32_16x16x32_bf16 v[200:203], v[168:171], v[104:107], v[200:203]
    v_mfma_f32_16x16x32_bf16 v[204:207], v[172:175], v[104:107], v[204:207]
    ds_read_b128 v[88:91], v12 offset:20480
    s_waitcnt lgkmcnt(4)
    v_mfma_f32_16x16x32_bf16 v[208:211], v[168:171], v[108:111], v[208:211]
    v_mul_f32 v128, s49, v128
    v_mul_f32 v129, s49, v129
    v_exp_f32 v128, v128
    v_mfma_f32_16x16x32_bf16 v[212:215], v[172:175], v[108:111], v[212:215]
    ds_read_b128 v[76:79], v13 offset:16384
    v_exp_f32 v129, v129
    v_mfma_f32_16x16x32_bf16 v[144:147], v[64:67], v[32:35], v[216:219]
    v_mul_f32 v130, s49, v130
    v_mul_f32 v131, s49, v131
    v_cvt_pk_bf16_f32 v160, v128, v129
    v_mfma_f32_16x16x32_bf16 v[152:155], v[64:67], v[48:51], v[216:219]
    ds_read_b128 v[92:95], v13 offset:20480
    v_exp_f32 v130, v130
    v_mfma_f32_16x16x32_bf16 v[148:151], v[80:83], v[32:35], v[220:223]
    v_exp_f32 v131, v131
    v_add_f32 v236, v236, v128
    v_add_f32 v237, v237, v129
    v_mul_f32 v132, s49, v132
    v_mfma_f32_16x16x32_bf16 v[156:159], v[80:83], v[48:51], v[220:223]
    ds_read_b128 v[176:179], v24 offset:0
    ds_read_b128 v[180:183], v24 offset:1024
    ds_read_b64_tr_b16 v[112:113], v18 offset:32768
    ds_read_b64_tr_b16 v[114:115], v18 offset:36864
    s_waitcnt lgkmcnt(7)
    v_mfma_f32_16x16x32_bf16 v[144:147], v[68:71], v[36:39], v[144:147]
    v_mfma_f32_16x16x32_bf16 v[152:155], v[68:71], v[52:55], v[152:155]
    ds_read_b64_tr_b16 v[116:117], v19 offset:32768
    ds_read_b64_tr_b16 v[118:119], v19 offset:36864
    v_mul_f32 v133, s49, v133
    v_cvt_pk_bf16_f32 v161, v130, v131
    v_mfma_f32_16x16x32_bf16 v[148:151], v[84:87], v[36:39], v[148:151]
    v_exp_f32 v132, v132
    v_exp_f32 v133, v133
    v_add_f32 v236, v236, v130
    v_mfma_f32_16x16x32_bf16 v[156:159], v[84:87], v[52:55], v[156:159]
    ds_read_b64_tr_b16 v[120:121], v20 offset:32768
    ds_read_b64_tr_b16 v[122:123], v20 offset:36864
    v_add_f32 v237, v237, v131
    v_mul_f32 v134, s49, v134
    v_mfma_f32_16x16x32_bf16 v[144:147], v[72:75], v[40:43], v[144:147]
    v_mul_f32 v135, s49, v135
    v_cvt_pk_bf16_f32 v162, v132, v133
    v_exp_f32 v134, v134
    v_mfma_f32_16x16x32_bf16 v[152:155], v[72:75], v[56:59], v[152:155]
    ds_read_b64_tr_b16 v[124:125], v21 offset:32768
    ds_read_b64_tr_b16 v[126:127], v21 offset:36864
    v_exp_f32 v135, v135
    s_waitcnt lgkmcnt(10)
    v_mfma_f32_16x16x32_bf16 v[148:151], v[88:91], v[40:43], v[148:151]
    v_add_f32 v236, v236, v132
    v_add_f32 v237, v237, v133
    v_mul_f32 v136, s49, v136
    v_mul_f32 v137, s49, v137
    v_cvt_pk_bf16_f32 v163, v134, v135
    v_mfma_f32_16x16x32_bf16 v[156:159], v[88:91], v[56:59], v[156:159]
    v_exp_f32 v136, v136
    v_exp_f32 v137, v137
    v_mfma_f32_16x16x32_bf16 v[144:147], v[76:79], v[44:47], v[144:147]
    ds_write_b128 v23, v[160:163] offset:25600
    v_mfma_f32_16x16x32_bf16 v[152:155], v[76:79], v[60:63], v[152:155]
    v_add_f32 v236, v236, v134
    v_add_f32 v237, v237, v135
    v_mul_f32 v138, s49, v138
    v_mul_f32 v139, s49, v139
    v_cvt_pk_bf16_f32 v164, v136, v137
    v_mfma_f32_16x16x32_bf16 v[148:151], v[92:95], v[44:47], v[148:151]
    v_exp_f32 v138, v138
    v_exp_f32 v139, v139
    v_mfma_f32_16x16x32_bf16 v[156:159], v[92:95], v[60:63], v[156:159]
    v_add_f32 v238, v238, v136
    v_add_f32 v239, v239, v137
    v_mul_f32 v140, s49, v140
    v_mul_f32 v141, s49, v141
    v_cvt_pk_bf16_f32 v165, v138, v139
    s_waitcnt lgkmcnt(3)
    v_mfma_f32_16x16x32_bf16 v[184:187], v[176:179], v[112:115], v[184:187]
    v_exp_f32 v140, v140
    v_exp_f32 v141, v141
    v_add_f32 v238, v238, v138
    v_mfma_f32_16x16x32_bf16 v[188:191], v[180:183], v[112:115], v[188:191]
    v_add_f32 v239, v239, v139
    v_mul_f32 v142, s49, v142
    v_mul_f32 v143, s49, v143
    v_cvt_pk_bf16_f32 v166, v140, v141
    v_mfma_f32_16x16x32_bf16 v[192:195], v[176:179], v[116:119], v[192:195]
    v_exp_f32 v142, v142
    v_exp_f32 v143, v143
    v_add_f32 v238, v238, v140
    v_mfma_f32_16x16x32_bf16 v[196:199], v[180:183], v[116:119], v[196:199]
    v_add_f32 v239, v239, v141
    v_cvt_pk_bf16_f32 v167, v142, v143
    ds_write_b128 v23, v[164:167] offset:26624
    v_mfma_f32_16x16x32_bf16 v[200:203], v[176:179], v[120:123], v[200:203]
    v_add_f32 v238, v238, v142
    v_add_f32 v239, v239, v143
    v_mfma_f32_16x16x32_bf16 v[204:207], v[180:183], v[120:123], v[204:207]
    s_waitcnt lgkmcnt(2)
    v_mfma_f32_16x16x32_bf16 v[208:211], v[176:179], v[124:127], v[208:211]
    v_mfma_f32_16x16x32_bf16 v[212:215], v[180:183], v[124:127], v[212:215]
    s_waitcnt lgkmcnt(0)
    s_barrier
    ds_read_b64_tr_b16 v[96:97], v14 offset:0
    ds_read_b64_tr_b16 v[98:99], v14 offset:4096
    ds_read_b64_tr_b16 v[100:101], v15 offset:0
    ds_read_b64_tr_b16 v[102:103], v15 offset:4096
    ds_read_b64_tr_b16 v[104:105], v16 offset:0
    ds_read_b64_tr_b16 v[106:107], v16 offset:4096
    ds_read_b64_tr_b16 v[108:109], v17 offset:0
    ds_read_b64_tr_b16 v[110:111], v17 offset:4096
    ds_read_b128 v[216:219], v22 offset:0
    ds_read_b128 v[220:223], v22 offset:64
    ds_read_b128 v[64:67], v10 offset:32768
    ds_read_b128 v[80:83], v10 offset:36864
    ds_read_b128 v[68:71], v11 offset:32768
    s_waitcnt lgkmcnt(7)
    v_mfma_f32_16x16x32_bf16 v[184:187], v[160:163], v[96:99], v[184:187]
    v_mfma_f32_16x16x32_bf16 v[188:191], v[164:167], v[96:99], v[188:191]
    ds_read_b128 v[84:87], v11 offset:36864
    v_mfma_f32_16x16x32_bf16 v[192:195], v[160:163], v[100:103], v[192:195]
    v_mfma_f32_16x16x32_bf16 v[196:199], v[164:167], v[100:103], v[196:199]
    ds_read_b128 v[72:75], v12 offset:32768
    v_mfma_f32_16x16x32_bf16 v[200:203], v[160:163], v[104:107], v[200:203]
    v_mfma_f32_16x16x32_bf16 v[204:207], v[164:167], v[104:107], v[204:207]
    ds_read_b128 v[88:91], v12 offset:36864
    s_waitcnt lgkmcnt(4)
    v_mfma_f32_16x16x32_bf16 v[208:211], v[160:163], v[108:111], v[208:211]
    v_mul_f32 v144, s49, v144
    v_mul_f32 v145, s49, v145
    v_exp_f32 v144, v144
    v_mfma_f32_16x16x32_bf16 v[212:215], v[164:167], v[108:111], v[212:215]
    ds_read_b128 v[76:79], v13 offset:32768
    v_exp_f32 v145, v145
    v_mfma_f32_16x16x32_bf16 v[128:131], v[64:67], v[32:35], v[216:219]
    v_mul_f32 v146, s49, v146
    v_mul_f32 v147, s49, v147
    v_cvt_pk_bf16_f32 v168, v144, v145
    v_mfma_f32_16x16x32_bf16 v[136:139], v[64:67], v[48:51], v[216:219]
    ds_read_b128 v[92:95], v13 offset:36864
    v_exp_f32 v146, v146
    v_mfma_f32_16x16x32_bf16 v[132:135], v[80:83], v[32:35], v[220:223]
    v_exp_f32 v147, v147
    v_add_f32 v236, v236, v144
    v_add_f32 v237, v237, v145
    v_mul_f32 v148, s49, v148
    v_mfma_f32_16x16x32_bf16 v[140:143], v[80:83], v[48:51], v[220:223]
    ds_read_b128 v[176:179], v24 offset:25600
    ds_read_b128 v[180:183], v24 offset:26624
    ds_read_b64_tr_b16 v[112:113], v18 offset:0
    ds_read_b64_tr_b16 v[114:115], v18 offset:4096
    s_waitcnt lgkmcnt(7)
    v_mfma_f32_16x16x32_bf16 v[128:131], v[68:71], v[36:39], v[128:131]
    v_mfma_f32_16x16x32_bf16 v[136:139], v[68:71], v[52:55], v[136:139]
    ds_read_b64_tr_b16 v[116:117], v19 offset:0
    ds_read_b64_tr_b16 v[118:119], v19 offset:4096
    v_mul_f32 v149, s49, v149
    v_cvt_pk_bf16_f32 v169, v146, v147
    v_mfma_f32_16x16x32_bf16 v[132:135], v[84:87], v[36:39], v[132:135]
    v_exp_f32 v148, v148
    v_exp_f32 v149, v149
    v_add_f32 v236, v236, v146
    v_mfma_f32_16x16x32_bf16 v[140:143], v[84:87], v[52:55], v[140:143]
    ds_read_b64_tr_b16 v[120:121], v20 offset:0
    ds_read_b64_tr_b16 v[122:123], v20 offset:4096
    v_add_f32 v237, v237, v147
    v_mul_f32 v150, s49, v150
    v_mfma_f32_16x16x32_bf16 v[128:131], v[72:75], v[40:43], v[128:131]
    v_mul_f32 v151, s49, v151
    v_cvt_pk_bf16_f32 v170, v148, v149
    v_exp_f32 v150, v150
    v_mfma_f32_16x16x32_bf16 v[136:139], v[72:75], v[56:59], v[136:139]
    ds_read_b64_tr_b16 v[124:125], v21 offset:0
    ds_read_b64_tr_b16 v[126:127], v21 offset:4096
    v_exp_f32 v151, v151
    s_waitcnt lgkmcnt(10)
    v_mfma_f32_16x16x32_bf16 v[132:135], v[88:91], v[40:43], v[132:135]
    v_add_f32 v236, v236, v148
    v_add_f32 v237, v237, v149
    v_mul_f32 v152, s49, v152
    v_mul_f32 v153, s49, v153
    v_cvt_pk_bf16_f32 v171, v150, v151
    v_mfma_f32_16x16x32_bf16 v[140:143], v[88:91], v[56:59], v[140:143]
    v_exp_f32 v152, v152
    v_exp_f32 v153, v153
    v_mfma_f32_16x16x32_bf16 v[128:131], v[76:79], v[44:47], v[128:131]
    ds_write_b128 v23, v[168:171] offset:0
    v_mfma_f32_16x16x32_bf16 v[136:139], v[76:79], v[60:63], v[136:139]
    v_add_f32 v236, v236, v150
    v_add_f32 v237, v237, v151
    v_mul_f32 v154, s49, v154
    v_mul_f32 v155, s49, v155
    v_cvt_pk_bf16_f32 v172, v152, v153
    v_mfma_f32_16x16x32_bf16 v[132:135], v[92:95], v[44:47], v[132:135]
    v_exp_f32 v154, v154
    v_exp_f32 v155, v155
    v_mfma_f32_16x16x32_bf16 v[140:143], v[92:95], v[60:63], v[140:143]
    v_add_f32 v238, v238, v152
    v_add_f32 v239, v239, v153
    v_mul_f32 v156, s49, v156
    v_mul_f32 v157, s49, v157
    v_cvt_pk_bf16_f32 v173, v154, v155
    s_waitcnt lgkmcnt(3)
    v_mfma_f32_16x16x32_bf16 v[184:187], v[176:179], v[112:115], v[184:187]
    v_exp_f32 v156, v156
    v_exp_f32 v157, v157
    v_add_f32 v238, v238, v154
    v_mfma_f32_16x16x32_bf16 v[188:191], v[180:183], v[112:115], v[188:191]
    v_add_f32 v239, v239, v155
    v_mul_f32 v158, s49, v158
    v_mul_f32 v159, s49, v159
    v_cvt_pk_bf16_f32 v174, v156, v157
    v_mfma_f32_16x16x32_bf16 v[192:195], v[176:179], v[116:119], v[192:195]
    v_exp_f32 v158, v158
    v_exp_f32 v159, v159
    v_add_f32 v238, v238, v156
    v_mfma_f32_16x16x32_bf16 v[196:199], v[180:183], v[116:119], v[196:199]
    v_add_f32 v239, v239, v157
    v_cvt_pk_bf16_f32 v175, v158, v159
    ds_write_b128 v23, v[172:175] offset:1024
    v_mfma_f32_16x16x32_bf16 v[200:203], v[176:179], v[120:123], v[200:203]
    v_add_f32 v238, v238, v158
    v_add_f32 v239, v239, v159
    v_mfma_f32_16x16x32_bf16 v[204:207], v[180:183], v[120:123], v[204:207]
    s_waitcnt lgkmcnt(2)
    v_mfma_f32_16x16x32_bf16 v[208:211], v[176:179], v[124:127], v[208:211]
    v_mfma_f32_16x16x32_bf16 v[212:215], v[180:183], v[124:127], v[212:215]
    s_waitcnt lgkmcnt(0)
    s_barrier
    ds_read_b64_tr_b16 v[96:97], v14 offset:16384
    ds_read_b64_tr_b16 v[98:99], v14 offset:20480
    ds_read_b64_tr_b16 v[100:101], v15 offset:16384
    ds_read_b64_tr_b16 v[102:103], v15 offset:20480
    ds_read_b64_tr_b16 v[104:105], v16 offset:16384
    ds_read_b64_tr_b16 v[106:107], v16 offset:20480
    ds_read_b64_tr_b16 v[108:109], v17 offset:16384
    ds_read_b64_tr_b16 v[110:111], v17 offset:20480
    ds_read_b128 v[216:219], v22 offset:256
    ds_read_b128 v[220:223], v22 offset:320
    ds_read_b128 v[64:67], v10 offset:49152
    ds_read_b128 v[80:83], v10 offset:53248
    ds_read_b128 v[68:71], v11 offset:49152
    s_waitcnt lgkmcnt(7)
    v_mfma_f32_16x16x32_bf16 v[184:187], v[168:171], v[96:99], v[184:187]
    v_mfma_f32_16x16x32_bf16 v[188:191], v[172:175], v[96:99], v[188:191]
    ds_read_b128 v[84:87], v11 offset:53248
    v_mfma_f32_16x16x32_bf16 v[192:195], v[168:171], v[100:103], v[192:195]
    v_mfma_f32_16x16x32_bf16 v[196:199], v[172:175], v[100:103], v[196:199]
    ds_read_b128 v[72:75], v12 offset:49152
    v_mfma_f32_16x16x32_bf16 v[200:203], v[168:171], v[104:107], v[200:203]
    v_mfma_f32_16x16x32_bf16 v[204:207], v[172:175], v[104:107], v[204:207]
    ds_read_b128 v[88:91], v12 offset:53248
    s_waitcnt lgkmcnt(4)
    v_mfma_f32_16x16x32_bf16 v[208:211], v[168:171], v[108:111], v[208:211]
    v_mul_f32 v128, s49, v128
    v_mul_f32 v129, s49, v129
    v_exp_f32 v128, v128
    v_mfma_f32_16x16x32_bf16 v[212:215], v[172:175], v[108:111], v[212:215]
    ds_read_b128 v[76:79], v13 offset:49152
    v_exp_f32 v129, v129
    v_mfma_f32_16x16x32_bf16 v[144:147], v[64:67], v[32:35], v[216:219]
    v_mul_f32 v130, s49, v130
    v_mul_f32 v131, s49, v131
    v_cvt_pk_bf16_f32 v160, v128, v129
    v_mfma_f32_16x16x32_bf16 v[152:155], v[64:67], v[48:51], v[216:219]
    ds_read_b128 v[92:95], v13 offset:53248
    v_exp_f32 v130, v130
    v_mfma_f32_16x16x32_bf16 v[148:151], v[80:83], v[32:35], v[220:223]
    v_exp_f32 v131, v131
    v_add_f32 v236, v236, v128
    v_add_f32 v237, v237, v129
    v_mul_f32 v132, s49, v132
    v_mfma_f32_16x16x32_bf16 v[156:159], v[80:83], v[48:51], v[220:223]
    ds_read_b128 v[176:179], v24 offset:0
    ds_read_b128 v[180:183], v24 offset:1024
    ds_read_b64_tr_b16 v[112:113], v18 offset:16384
    ds_read_b64_tr_b16 v[114:115], v18 offset:20480
    s_waitcnt lgkmcnt(7)
    v_mfma_f32_16x16x32_bf16 v[144:147], v[68:71], v[36:39], v[144:147]
    v_mfma_f32_16x16x32_bf16 v[152:155], v[68:71], v[52:55], v[152:155]
    ds_read_b64_tr_b16 v[116:117], v19 offset:16384
    ds_read_b64_tr_b16 v[118:119], v19 offset:20480
    v_mul_f32 v133, s49, v133
    v_cvt_pk_bf16_f32 v161, v130, v131
    v_mfma_f32_16x16x32_bf16 v[148:151], v[84:87], v[36:39], v[148:151]
    v_exp_f32 v132, v132
    v_exp_f32 v133, v133
    v_add_f32 v236, v236, v130
    v_mfma_f32_16x16x32_bf16 v[156:159], v[84:87], v[52:55], v[156:159]
    ds_read_b64_tr_b16 v[120:121], v20 offset:16384
    ds_read_b64_tr_b16 v[122:123], v20 offset:20480
    v_add_f32 v237, v237, v131
    v_mul_f32 v134, s49, v134
    v_mfma_f32_16x16x32_bf16 v[144:147], v[72:75], v[40:43], v[144:147]
    v_mul_f32 v135, s49, v135
    v_cvt_pk_bf16_f32 v162, v132, v133
    v_exp_f32 v134, v134
    v_mfma_f32_16x16x32_bf16 v[152:155], v[72:75], v[56:59], v[152:155]
    ds_read_b64_tr_b16 v[124:125], v21 offset:16384
    ds_read_b64_tr_b16 v[126:127], v21 offset:20480
    v_exp_f32 v135, v135
    s_waitcnt lgkmcnt(10)
    v_mfma_f32_16x16x32_bf16 v[148:151], v[88:91], v[40:43], v[148:151]
    v_add_f32 v236, v236, v132
    v_add_f32 v237, v237, v133
    v_mul_f32 v136, s49, v136
    v_mul_f32 v137, s49, v137
    v_cvt_pk_bf16_f32 v163, v134, v135
    v_mfma_f32_16x16x32_bf16 v[156:159], v[88:91], v[56:59], v[156:159]
    v_exp_f32 v136, v136
    v_exp_f32 v137, v137
    v_mfma_f32_16x16x32_bf16 v[144:147], v[76:79], v[44:47], v[144:147]
    ds_write_b128 v23, v[160:163] offset:25600
    v_mfma_f32_16x16x32_bf16 v[152:155], v[76:79], v[60:63], v[152:155]
    v_add_f32 v236, v236, v134
    v_add_f32 v237, v237, v135
    v_mul_f32 v138, s49, v138
    v_mul_f32 v139, s49, v139
    v_cvt_pk_bf16_f32 v164, v136, v137
    v_mfma_f32_16x16x32_bf16 v[148:151], v[92:95], v[44:47], v[148:151]
    v_exp_f32 v138, v138
    v_exp_f32 v139, v139
    v_mfma_f32_16x16x32_bf16 v[156:159], v[92:95], v[60:63], v[156:159]
    v_add_f32 v238, v238, v136
    v_add_f32 v239, v239, v137
    v_mul_f32 v140, s49, v140
    v_mul_f32 v141, s49, v141
    v_cvt_pk_bf16_f32 v165, v138, v139
    s_waitcnt lgkmcnt(3)
    v_mfma_f32_16x16x32_bf16 v[184:187], v[176:179], v[112:115], v[184:187]
    v_exp_f32 v140, v140
    v_exp_f32 v141, v141
    v_add_f32 v238, v238, v138
    v_mfma_f32_16x16x32_bf16 v[188:191], v[180:183], v[112:115], v[188:191]
    v_add_f32 v239, v239, v139
    v_mul_f32 v142, s49, v142
    v_mul_f32 v143, s49, v143
    v_cvt_pk_bf16_f32 v166, v140, v141
    v_mfma_f32_16x16x32_bf16 v[192:195], v[176:179], v[116:119], v[192:195]
    v_exp_f32 v142, v142
    v_exp_f32 v143, v143
    v_add_f32 v238, v238, v140
    v_mfma_f32_16x16x32_bf16 v[196:199], v[180:183], v[116:119], v[196:199]
    v_add_f32 v239, v239, v141
    v_cvt_pk_bf16_f32 v167, v142, v143
    ds_write_b128 v23, v[164:167] offset:26624
    v_mfma_f32_16x16x32_bf16 v[200:203], v[176:179], v[120:123], v[200:203]
    v_add_f32 v238, v238, v142
    v_add_f32 v239, v239, v143
    v_mfma_f32_16x16x32_bf16 v[204:207], v[180:183], v[120:123], v[204:207]
    s_waitcnt lgkmcnt(2)
    v_mfma_f32_16x16x32_bf16 v[208:211], v[176:179], v[124:127], v[208:211]
    v_mfma_f32_16x16x32_bf16 v[212:215], v[180:183], v[124:127], v[212:215]
    s_waitcnt lgkmcnt(0)
    s_barrier
    ds_read_b64_tr_b16 v[96:97], v14 offset:58368
    ds_read_b64_tr_b16 v[98:99], v14 offset:62464
    ds_read_b64_tr_b16 v[100:101], v15 offset:58368
    ds_read_b64_tr_b16 v[102:103], v15 offset:62464
    ds_read_b64_tr_b16 v[104:105], v16 offset:58368
    ds_read_b64_tr_b16 v[106:107], v16 offset:62464
    ds_read_b64_tr_b16 v[108:109], v17 offset:58368
    ds_read_b64_tr_b16 v[110:111], v17 offset:62464
    ds_read_b128 v[176:179], v24 offset:25600
    ds_read_b128 v[180:183], v24 offset:26624
    ds_read_b64_tr_b16 v[112:113], v18 offset:58368
    ds_read_b64_tr_b16 v[114:115], v18 offset:62464
    ds_read_b64_tr_b16 v[116:117], v19 offset:58368
    ds_read_b64_tr_b16 v[118:119], v19 offset:62464
    ds_read_b64_tr_b16 v[120:121], v20 offset:58368
    ds_read_b64_tr_b16 v[122:123], v20 offset:62464
    s_waitcnt lgkmcnt(10)
    v_mfma_f32_16x16x32_bf16 v[184:187], v[160:163], v[96:99], v[184:187]
    v_mfma_f32_16x16x32_bf16 v[188:191], v[164:167], v[96:99], v[188:191]
    ds_read_b64_tr_b16 v[124:125], v21 offset:58368
    ds_read_b64_tr_b16 v[126:127], v21 offset:62464
    v_mfma_f32_16x16x32_bf16 v[192:195], v[160:163], v[100:103], v[192:195]
    v_mul_f32 v144, s49, v144
    v_mul_f32 v145, s49, v145
    v_exp_f32 v144, v144
    v_mfma_f32_16x16x32_bf16 v[196:199], v[164:167], v[100:103], v[196:199]
    v_exp_f32 v145, v145
    v_mul_f32 v146, s49, v146
    v_mul_f32 v147, s49, v147
    v_cvt_pk_bf16_f32 v168, v144, v145
    v_exp_f32 v146, v146
    v_mfma_f32_16x16x32_bf16 v[200:203], v[160:163], v[104:107], v[200:203]
    v_exp_f32 v147, v147
    v_add_f32 v236, v236, v144
    v_add_f32 v237, v237, v145
    v_mul_f32 v148, s49, v148
    v_mul_f32 v149, s49, v149
    v_cvt_pk_bf16_f32 v169, v146, v147
    v_exp_f32 v148, v148
    v_mfma_f32_16x16x32_bf16 v[204:207], v[164:167], v[104:107], v[204:207]
    v_exp_f32 v149, v149
    v_add_f32 v236, v236, v146
    v_add_f32 v237, v237, v147
    v_mul_f32 v150, s49, v150
    v_mul_f32 v151, s49, v151
    v_cvt_pk_bf16_f32 v170, v148, v149
    s_waitcnt lgkmcnt(4)
    v_mfma_f32_16x16x32_bf16 v[208:211], v[160:163], v[108:111], v[208:211]
    v_exp_f32 v150, v150
    v_exp_f32 v151, v151
    v_add_f32 v236, v236, v148
    v_add_f32 v237, v237, v149
    v_mul_f32 v152, s49, v152
    v_mul_f32 v153, s49, v153
    v_mfma_f32_16x16x32_bf16 v[212:215], v[164:167], v[108:111], v[212:215]
    v_cvt_pk_bf16_f32 v171, v150, v151
    v_exp_f32 v152, v152
    v_exp_f32 v153, v153
    ds_write_b128 v23, v[168:171] offset:0
    v_mfma_f32_16x16x32_bf16 v[184:187], v[176:179], v[112:115], v[184:187]
    v_add_f32 v236, v236, v150
    v_add_f32 v237, v237, v151
    v_mul_f32 v154, s49, v154
    v_mul_f32 v155, s49, v155
    v_cvt_pk_bf16_f32 v172, v152, v153
    v_exp_f32 v154, v154
    v_mfma_f32_16x16x32_bf16 v[188:191], v[180:183], v[112:115], v[188:191]
    v_exp_f32 v155, v155
    v_add_f32 v238, v238, v152
    v_add_f32 v239, v239, v153
    v_mul_f32 v156, s49, v156
    v_mul_f32 v157, s49, v157
    v_cvt_pk_bf16_f32 v173, v154, v155
    v_mfma_f32_16x16x32_bf16 v[192:195], v[176:179], v[116:119], v[192:195]
    v_exp_f32 v156, v156
    v_exp_f32 v157, v157
    v_add_f32 v238, v238, v154
    v_add_f32 v239, v239, v155
    v_mul_f32 v158, s49, v158
    v_mul_f32 v159, s49, v159
    v_mfma_f32_16x16x32_bf16 v[196:199], v[180:183], v[116:119], v[196:199]
    v_cvt_pk_bf16_f32 v174, v156, v157
    v_exp_f32 v158, v158
    v_exp_f32 v159, v159
    v_add_f32 v238, v238, v156
    v_add_f32 v239, v239, v157
    v_cvt_pk_bf16_f32 v175, v158, v159
    s_waitcnt lgkmcnt(1)
    v_mfma_f32_16x16x32_bf16 v[200:203], v[176:179], v[120:123], v[200:203]
    ds_write_b128 v23, v[172:175] offset:1024
    v_add_f32 v238, v238, v158
    v_add_f32 v239, v239, v159
    v_mfma_f32_16x16x32_bf16 v[204:207], v[180:183], v[120:123], v[204:207]
    v_mfma_f32_16x16x32_bf16 v[208:211], v[176:179], v[124:127], v[208:211]
    v_mfma_f32_16x16x32_bf16 v[212:215], v[180:183], v[124:127], v[212:215]
    ds_read_b32 v252, v31 offset:4
    v_add_f32 v26, v236, v237
    v_add_f32 v27, v238, v239
    v_mov_b32 v4, v26
    v_mov_b32 v5, v27
    s_nop 0
    v_permlane16_swap_b32 v26, v4
    v_permlane16_swap_b32 v27, v5
    v_add_f32 v26, v26, v4
    v_add_f32 v27, v27, v5
    v_mov_b32 v4, v26
    v_mov_b32 v5, v27
    s_nop 0
    v_permlane32_swap_b32 v26, v4
    v_permlane32_swap_b32 v27, v5
    v_add_f32 v26, v26, v4
    v_add_f32 v27, v27, v5
    s_mov_b32 vcc_lo, 0xffff0000
    s_mov_b32 vcc_hi, 0xffff0000
    v_cndmask_b32 v26, v26, v27, vcc
    ds_write_b32 v30, v26
    s_waitcnt lgkmcnt(0)
    v_readfirstlane_b32 s88, v252
    s_mov_b32 s59, 1
    s_lshr_b32 s47, s88, s58
    s_and_b32 s47, s47, 15
    s_cmp_lg_u32 s47, 8
    s_cbranch_scc1 L_notlocal
L_decided:
    s_waitcnt lgkmcnt(0)
    s_setprio 3
    s_barrier
    ds_read_b64_tr_b16 v[100:101], v15 offset:32768
    ds_read_b64_tr_b16 v[102:103], v15 offset:36864
    ds_read_b64_tr_b16 v[104:105], v16 offset:32768
    ds_read_b64_tr_b16 v[106:107], v16 offset:36864
    ds_read_b128 v[176:179], v24 offset:0
    ds_read_b128 v[180:183], v24 offset:1024
    ds_read_b64_tr_b16 v[116:117], v19 offset:32768
    ds_read_b64_tr_b16 v[118:119], v19 offset:36864
    ds_read_b64_tr_b16 v[120:121], v20 offset:32768
    ds_read_b64_tr_b16 v[122:123], v20 offset:36864
    ds_read_b64_tr_b16 v[108:109], v17 offset:32768
    ds_read_b64_tr_b16 v[110:111], v17 offset:36864
    ds_read_b64_tr_b16 v[124:125], v21 offset:32768
    ds_read_b64_tr_b16 v[126:127], v21 offset:36864
    s_waitcnt lgkmcnt(12)
    v_mfma_f32_16x16x32_bf16 v[192:195], v[168:171], v[100:103], v[192:195]
    v_mfma_f32_16x16x32_bf16 v[196:199], v[172:175], v[100:103], v[196:199]
    s_waitcnt lgkmcnt(6)
    v_mfma_f32_16x16x32_bf16 v[192:195], v[176:179], v[116:119], v[192:195]
    v_mfma_f32_16x16x32_bf16 v[196:199], v[180:183], v[116:119], v[196:199]
    ds_read_b64_tr_b16 v[96:97], v14 offset:32768
    ds_read_b64_tr_b16 v[98:99], v14 offset:36864
    ds_read_b64_tr_b16 v[112:113], v18 offset:32768
    ds_read_b64_tr_b16 v[114:115], v18 offset:36864
    ds_read_b32 v27, v25
    v_mfma_f32_16x16x32_bf16 v[200:203], v[168:171], v[104:107], v[200:203]
    v_mfma_f32_16x16x32_bf16 v[204:207], v[172:175], v[104:107], v[204:207]
    s_waitcnt lgkmcnt(9)
    v_mfma_f32_16x16x32_bf16 v[200:203], v[176:179], v[120:123], v[200:203]
    v_mfma_f32_16x16x32_bf16 v[204:207], v[180:183], v[120:123], v[204:207]
    s_waitcnt lgkmcnt(7)
    v_mfma_f32_16x16x32_bf16 v[208:211], v[168:171], v[108:111], v[208:211]
    v_cvt_pk_bf16_f32 v68, v192, v193
    v_cvt_pk_bf16_f32 v69, v194, v195
    v_mfma_f32_16x16x32_bf16 v[212:215], v[172:175], v[108:111], v[212:215]
    v_cvt_pk_bf16_f32 v70, v196, v197
    v_cvt_pk_bf16_f32 v71, v198, v199
    s_waitcnt lgkmcnt(5)
    v_mfma_f32_16x16x32_bf16 v[208:211], v[176:179], v[124:127], v[208:211]
    v_min_u32 v68, -2, v68
    v_min_u32 v69, -2, v69
    v_mfma_f32_16x16x32_bf16 v[212:215], v[180:183], v[124:127], v[212:215]
    v_min_u32 v70, -2, v70
    v_min_u32 v71, -2, v71
    s_waitcnt lgkmcnt(3)
    v_mfma_f32_16x16x32_bf16 v[184:187], v[168:171], v[96:99], v[184:187]
    v_cvt_pk_bf16_f32 v72, v200, v201
    v_cvt_pk_bf16_f32 v73, v202, v203
    v_mfma_f32_16x16x32_bf16 v[188:191], v[172:175], v[96:99], v[188:191]
    v_cvt_pk_bf16_f32 v74, v204, v205
    v_cvt_pk_bf16_f32 v75, v206, v207
    s_waitcnt lgkmcnt(1)
    v_mfma_f32_16x16x32_bf16 v[184:187], v[176:179], v[112:115], v[184:187]
    v_min_u32 v72, -2, v72
    v_min_u32 v73, -2, v73
    v_mfma_f32_16x16x32_bf16 v[188:191], v[180:183], v[112:115], v[188:191]
    v_min_u32 v74, -2, v74
    v_min_u32 v75, -2, v75
    v_cvt_pk_bf16_f32 v76, v208, v209
    v_cvt_pk_bf16_f32 v77, v210, v211
    v_cvt_pk_bf16_f32 v78, v212, v213
    v_cvt_pk_bf16_f32 v79, v214, v215
    v_min_u32 v76, -2, v76
    v_min_u32 v77, -2, v77
    v_min_u32 v78, -2, v78
    v_min_u32 v79, -2, v79
    s_waitcnt lgkmcnt(0)
    v_add_f32 v26, v26, v27
    v_min_u32 v27, -2, v26
    s_cmp_eq_u32 s59, 0
    s_cbranch_scc1 L_gen_pub
    buffer_store_dwordx4 v[68:71], v6, s[36:39], s4 offen offset:256
    buffer_store_dwordx4 v[72:75], v6, s[36:39], s4 offen offset:1280
    buffer_store_dwordx4 v[76:79], v6, s[36:39], s4 offen offset:2304
    buffer_store_dword v27, v7, s[36:39], s4 offen offset:0
L_back_pub:
    s_mov_b32 s92, 0
L_A:
    buffer_load_dwordx4 v[32:35], v6, s[36:39], s6 offen offset:256 sc1
    buffer_load_dword v44, v7, s[36:39], s6 offen offset:0 sc1
    buffer_load_dwordx4 v[36:39], v6, s[36:39], s8 offen offset:1280 sc1
    buffer_load_dword v45, v7, s[36:39], s8 offen offset:0 sc1
    buffer_load_dwordx4 v[40:43], v6, s[36:39], s10 offen offset:2304 sc1
    buffer_load_dword v46, v7, s[36:39], s10 offen offset:0 sc1
    s_waitcnt vmcnt(0)
    v_max3_u32 v4, v32, v33, v34
    v_max3_u32 v4, v4, v35, v36
    v_max3_u32 v4, v4, v37, v38
    v_max3_u32 v4, v4, v39, v40
    v_max3_u32 v4, v4, v41, v42
    v_max3_u32 v4, v4, v43, v44
    v_max3_u32 v4, v4, v45, v46
    v_cmp_eq_u32 vcc, -1, v4
    s_add_u32 s92, s92, 1
    s_cmp_ge_u32 s92, 300000
    s_cbranch_scc1 L_A_ok
    s_cbranch_vccnz L_A
L_A_ok:
    v_dot2c_f32_bf16 v184, s12, v32
    v_dot2c_f32_bf16 v185, s13, v32
    v_dot2c_f32_bf16 v186, s12, v33
    v_dot2c_f32_bf16 v187, s13, v33
    v_dot2c_f32_bf16 v188, s12, v34
    v_dot2c_f32_bf16 v189, s13, v34
    v_dot2c_f32_bf16 v190, s12, v35
    v_dot2c_f32_bf16 v191, s13, v35
    v_add_f32 v26, v26, v44
    v_dot2c_f32_bf16 v184, s12, v36
    v_dot2c_f32_bf16 v185, s13, v36
    v_dot2c_f32_bf16 v186, s12, v37
    v_dot2c_f32_bf16 v187, s13, v37
    v_dot2c_f32_bf16 v188, s12, v38
    v_dot2c_f32_bf16 v189, s13, v38
    v_dot2c_f32_bf16 v190, s12, v39
    v_dot2c_f32_bf16 v191, s13, v39
    v_add_f32 v26, v26, v45
    v_dot2c_f32_bf16 v184, s12, v40
    v_dot2c_f32_bf16 v185, s13, v40
    v_dot2c_f32_bf16 v186, s12, v41
    v_dot2c_f32_bf16 v187, s13, v41
    v_dot2c_f32_bf16 v188, s12, v42
    v_dot2c_f32_bf16 v189, s13, v42
    v_dot2c_f32_bf16 v190, s12, v43
    v_dot2c_f32_bf16 v191, s13, v43
    v_add_f32 v26, v26, v46
    v_cvt_pk_bf16_f32 v80, v184, v185
    v_cvt_pk_bf16_f32 v81, v186, v187
    v_cvt_pk_bf16_f32 v82, v188, v189
    v_cvt_pk_bf16_f32 v83, v190, v191
    v_cvt_pk_bf16_f32 v26, v26, v26
    v_min_u32 v80, -2, v80
    v_min_u32 v81, -2, v81
    v_min_u32 v82, -2, v82
    v_min_u32 v83, -2, v83
    v_min_u32 v26, -2, v26
    s_cmp_eq_u32 s59, 0
    s_cbranch_scc1 L_gen_h2
    buffer_store_dwordx4 v[80:83], v6, s[36:39], s4 offen offset:3328
    buffer_store_dword v26, v7, s[36:39], s4 offen offset:128
L_back_h2:
    ds_write_b128 v224, v[80:83]
    ds_write_b16 v28, v26
L_B:
    buffer_load_dwordx4 v[96:99], v6, s[36:39], s5 offen offset:3328 sc1
    buffer_load_dwordx4 v[100:103], v6, s[36:39], s6 offen offset:3328 sc1
    buffer_load_dwordx4 v[104:107], v6, s[36:39], s7 offen offset:3328 sc1
    buffer_load_dwordx4 v[108:111], v6, s[36:39], s8 offen offset:3328 sc1
    buffer_load_dwordx4 v[112:115], v6, s[36:39], s9 offen offset:3328 sc1
    buffer_load_dwordx4 v[116:119], v6, s[36:39], s10 offen offset:3328 sc1
    buffer_load_dwordx4 v[120:123], v6, s[36:39], s11 offen offset:3328 sc1
    buffer_load_dword v124, v7, s[36:39], s5 offen offset:128 sc1
    s_waitcnt vmcnt(0)
    v_max3_u32 v4, v96, v97, v98
    v_max3_u32 v4, v4, v99, v100
    v_max3_u32 v4, v4, v101, v102
    v_max3_u32 v4, v4, v103, v104
    v_max3_u32 v4, v4, v105, v106
    v_max3_u32 v4, v4, v107, v108
    v_max3_u32 v4, v4, v109, v110
    v_max3_u32 v4, v4, v111, v112
    v_max3_u32 v4, v4, v113, v114
    v_max3_u32 v4, v4, v115, v116
    v_max3_u32 v4, v4, v117, v118
    v_max3_u32 v4, v4, v119, v120
    v_max3_u32 v4, v4, v121, v122
    v_max3_u32 v4, v4, v123, v124
    v_cmp_eq_u32 vcc, -1, v4
    s_add_u32 s92, s92, 1
    s_cmp_ge_u32 s92, 300000
    s_cbranch_scc1 L_B_ok
    s_cbranch_vccnz L_B
L_B_ok:
    ds_write_b128 v225, v[96:99]
    ds_write_b128 v226, v[100:103]
    ds_write_b128 v227, v[104:107]
    ds_write_b128 v228, v[108:111]
    ds_write_b128 v229, v[112:115]
    ds_write_b128 v230, v[116:119]
    ds_write_b128 v231, v[120:123]
    ds_write_b16 v29, v124
    s_waitcnt lgkmcnt(0)
    s_barrier
    s_endpgm
L_gen_pub:
    buffer_store_dwordx4 v[68:71], v6, s[36:39], s4 offen offset:256 sc1
    buffer_store_dwordx4 v[72:75], v6, s[36:39], s4 offen offset:1280 sc1
    buffer_store_dwordx4 v[76:79], v6, s[36:39], s4 offen offset:2304 sc1
    buffer_store_dword v27, v7, s[36:39], s4 offen offset:0 sc1
    s_branch L_back_pub
L_gen_h2:
    buffer_store_dwordx4 v[80:83], v6, s[36:39], s4 offen offset:3328 sc1
    buffer_store_dword v26, v7, s[36:39], s4 offen offset:128 sc1
    s_branch L_back_h2
L_notlocal:
    s_mov_b32 s92, 0
L_nl1:
    s_lshr_b32 s47, s88, s58
    s_and_b32 s47, s47, 15
    s_cmp_eq_u32 s47, 8
    s_cbranch_scc1 L_decided
    s_and_b32 s47, s88, 0x0f0f0f0f
    s_lshr_b32 s48, s88, 4
    s_and_b32 s48, s48, 0x0f0f0f0f
    s_add_u32 s47, s47, s48
    s_mul_i32 s47, s47, 0x01010101
    s_lshr_b32 s47, s47, 24
    s_cmp_ge_u32 s47, 8
    s_cbranch_scc1 L_nl2
    s_add_u32 s92, s92, 1
    s_cmp_ge_u32 s92, 200000
    s_cbranch_scc1 L_nl2
    buffer_load_dword v252, v9, s[40:43], s65 offen sc1
    s_waitcnt vmcnt(0)
    v_readfirstlane_b32 s88, v252
    s_branch L_nl1
L_nl2:
    s_mov_b32 s59, 0
    buffer_store_dwordx4 v[232:235], v6, s[36:39], s4 offen offset:256 sc1
    buffer_store_dwordx4 v[232:235], v6, s[36:39], s4 offen offset:1280 sc1
    buffer_store_dwordx4 v[232:235], v6, s[36:39], s4 offen offset:2304 sc1
    buffer_store_dwordx4 v[232:235], v6, s[36:39], s4 offen offset:3328 sc1
    buffer_store_dword v232, v8, s[36:39], s4 offen sc1
    v_mov_b32 v4, 1
    s_waitcnt vmcnt(0)
    s_mov_b64 exec, 1
    buffer_atomic_add v4, v9, s[40:43], s65 offen offset:4 sc1
    s_mov_b64 exec, -1
L_nl3:
    buffer_load_dword v252, v9, s[40:43], s65 offen offset:4 sc1
    s_waitcnt vmcnt(0)
    v_readfirstlane_b32 s47, v252
    s_nop 0
    s_cmp_ge_u32 s47, 32
    s_cbranch_scc1 L_decided
    s_add_u32 s92, s92, 1
    s_cmp_ge_u32 s92, 400000
    s_cbranch_scc1 L_decided
    s_sleep 8
    s_branch L_nl3
.fill ((35840 - (. - standalone__linear_kernel_performer__prompt_kernel)) / 4), 4, 0xbf810000
.section .rodata,"a"
.p2align 6
.amdhsa_kernel standalone__linear_kernel_performer__prompt_kernel
  .amdhsa_next_free_vgpr 256
  .amdhsa_next_free_sgpr 102
  .amdhsa_accum_offset 256
  .amdhsa_group_segment_fixed_size 0
  .amdhsa_kernarg_size 56
  .amdhsa_user_sgpr_count 2
  .amdhsa_user_sgpr_kernarg_segment_ptr 1
  .amdhsa_system_sgpr_workgroup_id_x 1
.end_amdhsa_kernel
```
